```python
import torch

def _softmax(x, axis=-1):
    return torch.softmax(x, dim=axis)
def _gelu(x):
    return torch.nn.functional.gelu(x, approximate="tanh")
def _silu(x):
    return torch.nn.functional.silu(x)
def _sigmoid(x):
    return torch.sigmoid(x)
def _layernorm(x, axis=-1, eps=1e-5):
    m = x.mean(dim=axis, keepdim=True)
    v = x.var(dim=axis, keepdim=True, unbiased=False)
    return (x - m) / torch.sqrt(v + eps)
def _scatter_add(tgt, idx, src, axis=0):
    return tgt.clone().index_add_(axis, idx, src)
def _segment_sum(src, seg, n):
    out = torch.zeros((n,) + src.shape[1:], dtype=src.dtype)
    return out.index_add_(0, seg, src)
def _pad(x, pw):
    flat = tuple(v for pair in reversed(pw) for v in pair)
    return torch.nn.functional.pad(x, flat)

kernel_name = 'parallel_sum__grouped_kv_mqa__glu_gated_swiglu__prompt'

def setup_inputs():

    _w = (lambda a: (lambda t: t.to(torch.bfloat16) if t.is_floating_point() else t)(torch.as_tensor(a)))
    def _A_setup():
        B, S, D, H = 1, 2048, 640, 32
        Dh = D // H
        return {
            "x": _w((lambda *s: torch.randn(*s, dtype=torch.bfloat16) * 0.05)(B, S, D)),
            "wq": _w((lambda *s: torch.randn(*s, dtype=torch.bfloat16) * 0.05)(D, H * Dh)),
            "wk": _w((lambda *s: torch.randn(*s, dtype=torch.bfloat16) * 0.05)(D, Dh)),
            "wv": _w((lambda *s: torch.randn(*s, dtype=torch.bfloat16) * 0.05)(D, Dh)),
            "wo": _w((lambda *s: torch.randn(*s, dtype=torch.bfloat16) * 0.05)(H * Dh, D)),
        }
    _A_in = _A_setup()

    def _B_setup():
        B, S, D, F = 1, 2048, 640, 1536
        return {
            "x": _w((lambda *s: torch.randn(*s, dtype=torch.bfloat16) * 0.05)(B, S, D)),
            "w1": _w((lambda *s: torch.randn(*s, dtype=torch.bfloat16) * 0.4)(D, F) * (2.0 / D) ** 0.5),
            "w3": _w((lambda *s: torch.randn(*s, dtype=torch.bfloat16) * 0.4)(D, F) * (2.0 / D) ** 0.5),
            "w2": _w((lambda *s: torch.randn(*s, dtype=torch.bfloat16) * 0.4)(F, D) * (2.0 / F) ** 0.5),
        }
    _B_in = _B_setup()

    return {
        "A_x": _A_in["x"],
        "A_wq": _A_in["wq"],
        "A_wk": _A_in["wk"],
        "A_wv": _A_in["wv"],
        "A_wo": _A_in["wo"],
        "B_x": _B_in["x"],
        "B_w1": _B_in["w1"],
        "B_w3": _B_in["w3"],
        "B_w2": _B_in["w2"],
    }

def reference(A_x, A_wq, A_wk, A_wv, A_wo, B_x, B_w1, B_w3, B_w2):
    def _A_ref(x, wq, wk, wv, wo):
        B, S, D = x.shape
        H = 32
        Dh = D // H
        q = (lambda x, *d: x.permute(*d))((x @ wq).reshape(B, S, H, Dh), 0, 2, 1, 3)
        k = x @ wk
        v = x @ wv
        scores = torch.einsum("bhqd,bkd->bhqk", q, k) * (Dh ** -0.5)
        p = _softmax(scores, axis=-1)
        o = torch.einsum("bhqk,bkd->bhqd", p, v)
        return (lambda x, *d: x.permute(*d))(o, 0, 2, 1, 3).reshape(B, S, H * Dh) @ wo

    def _B_ref(x, w1, w3, w2):
        gate = torch.einsum("bsd,df->bsf", x, w1)
        up = torch.einsum("bsd,df->bsf", x, w3)
        h = _silu(gate) * up
        out = torch.einsum("bsf,fd->bsd", h, w2)
        return out

    x = A_x
    xn = _layernorm(x, axis=-1)
    return x + _A_ref(xn, A_wq, A_wk, A_wv, A_wo) + _B_ref(xn, B_w1, B_w3, B_w2)
```

```asm
; @launch grid=(256,1,1) block=(768,1,1) lds=163840
.amdgcn_target "amdgcn-amd-amdhsa--gfx950"
.text
.globl parallel_sum__grouped_kv_mqa__glu_gated_swiglu__prompt_kernel
.p2align 8
.type parallel_sum__grouped_kv_mqa__glu_gated_swiglu__prompt_kernel,@function
parallel_sum__grouped_kv_mqa__glu_gated_swiglu__prompt_kernel:
    s_cmp_ge_u32 s2, 256
    s_cbranch_scc1 K2_END
    s_load_dwordx16 s[16:31], s[0:1], 0
    s_load_dwordx2 s[32:33], s[0:1], 64
    s_load_dwordx4 s[12:15], s[0:1], 80
    v_lshrrev_b32 v1, 6, v0
    s_nop 0
    v_readfirstlane_b32 s52, v1
    v_and_b32 v0, 63, v0
    s_and_b32 s53, s52, 3
    s_lshr_b32 s54, s52, 2
    s_and_b32 s63, s2, 7
    s_lshr_b32 s67, s2, 3
    s_lshr_b32 s77, s67, 2
    s_and_b32 s68, s67, 3
    s_lshr_b32 s69, s63, 1
    s_mul_i32 s56, s69, 6
    s_add_u32 s56, s56, s77
    s_sub_u32 s56, s56, 2
    s_lshl_b32 s70, s69, 1
    s_add_u32 s70, s70, s77
    s_add_u32 s70, s70, 24
    s_cmp_lt_u32 s77, 2
    s_cselect_b32 s56, s70, s56
    s_and_b32 s55, s63, 1
    s_lshl_b32 s55, s55, 2
    s_add_u32 s55, s55, s68
    s_mov_b32 s76, 19731456
    s_mov_b32 s71, 0
    s_mov_b32 s66, 0x3f803f80
    s_lshl_b32 s64, s52, 12
    v_lshlrev_b32 v16, 4, v0
    v_mov_b32 v17, 0
    v_mov_b32 v18, 0
    v_mov_b32 v19, 0
    v_mov_b32 v20, 0
    v_mov_b32 v21, 0
    v_mov_b32 v22, 0
    s_waitcnt lgkmcnt(0)
    s_mov_b32 s48, s14
    s_mov_b32 s49, s15
    s_mov_b32 s50, 19891200
    s_mov_b32 s51, 0x00020000
    s_mov_b32 s36, s16
    s_mov_b32 s37, s17
    s_mov_b32 s38, 2621440
    s_mov_b32 s39, 0x00020000
    s_mov_b32 s72, s12
    s_mov_b32 s73, s13
    s_mov_b32 s74, 256
    s_mov_b32 s75, 0x00020000
    s_mov_b32 s57, 0
    s_or_b32 s63, s2, s52
    s_cmp_lg_u32 s63, 0
    s_cbranch_scc1 K1_NONONCE
    s_memrealtime s[4:5]
    s_waitcnt lgkmcnt(0)
    s_or_b32 s4, s4, 1
    s_mov_b64 exec, 1
    v_mov_b32 v1, s4
    v_mov_b32 v2, 0
    s_nop 1
    buffer_store_dword v1, v2, s[72:75], 0 offen sc0 sc1
    s_mov_b64 exec, -1
K1_NONONCE:
    s_cmp_lg_u32 s52, 0
    s_cbranch_scc1 K1_NOZC
    v_mov_b32 v1, 163328
    v_mov_b32 v2, 0
    s_nop 0
    ds_write_b32 v1, v2
    s_waitcnt lgkmcnt(0)
K1_NOZC:
    s_lshl_b32 s26, s55, 7
    s_lshl_b32 s63, s56, 2
    s_add_u32 s26, s26, s63
    s_lshl_b32 s63, s55, 2
    s_add_u32 s63, s63, 1024
    s_cmp_eq_u32 s56, 29
    s_cselect_b32 s26, s63, s26
    s_sub_u32 s67, s56, 30
    s_lshl_b32 s67, s67, 5
    s_add_u32 s63, s63, s67
    s_add_u32 s63, s63, 32
    s_cmp_ge_u32 s56, 30
    s_cselect_b32 s26, s63, s26
    s_add_u32 s26, s26, 19878912
    s_cmp_lt_u32 s56, 29
    s_cbranch_scc1 K1_REG
    s_cmp_lt_u32 s52, 8
    s_cbranch_scc1 K1_NR8
    s_barrier
    s_cmp_ge_u32 s56, 30
    s_cbranch_scc1 PB_G
    s_barrier
    s_barrier
    s_branch PB_G
K1_NR8:
    s_cmp_ge_u32 s56, 30
    s_cbranch_scc1 K1_RELAY
    v_lshrrev_b32 v1, 3, v0
    s_lshl_b32 s63, s55, 8
    s_lshl_b32 s67, s52, 5
    s_add_u32 s63, s63, s67
    v_add_u32 v1, s63, v1
    v_mul_u32_u24 v1, 1280, v1
    v_and_b32 v2, 7, v0
    v_lshrrev_b32 v3, 4, v0
    v_xor_b32 v2, v2, v3
    v_xor_b32 v4, 4, v2
    v_lshl_add_u32 v5, v2, 4, v1
    v_lshl_add_u32 v6, v4, 4, v1
    v_mov_b32 v1, v5
    v_add_u32 v2, 9216, v6
    v_add_u32 v3, 18432, v5
    v_add_u32 v4, 27648, v6
    s_branch K1_KV
K1_REG:
    s_cmp_ge_u32 s56, 24
    s_cbranch_scc1 K1_QSET
    s_mov_b32 s40, s28
    s_mov_b32 s41, s29
    s_mov_b32 s42, 1966080
    s_mov_b32 s43, 0x00020000
    s_mov_b32 s44, s30
    s_mov_b32 s45, s31
    s_mov_b32 s46, 1966080
    s_mov_b32 s47, 0x00020000
    s_mov_b32 s69, 3072
    s_lshl_b32 s70, s56, 7
    s_branch K1_SETDONE
K1_QSET:
    s_mov_b32 s40, s18
    s_mov_b32 s41, s19
    s_mov_b32 s42, 819200
    s_mov_b32 s43, 0x00020000
    s_add_u32 s44, s18, 128
    s_addc_u32 s45, s19, 0
    s_mov_b32 s46, 819072
    s_mov_b32 s47, 0x00020000
    s_mov_b32 s69, 1280
    s_sub_u32 s70, s56, 24
    s_lshl_b32 s70, s70, 8
K1_SETDONE:
    s_nop 0
    s_lshl_b32 s59, s69, 6
    s_cmp_ge_u32 s52, 8
    s_cbranch_scc1 K1_LOADER
    s_lshl_b32 s63, s55, 8
    s_lshl_b32 s67, s56, 3
    s_add_u32 s63, s63, s67
    s_add_u32 s63, s63, s52
    v_mov_b32 v23, s63
    s_mul_i32 s63, s63, 1280
    v_lshlrev_b32 v128, 5, v0
    v_mov_b32 v129, 0x7f000000
    v_cmp_gt_u32 vcc, 40, v0
    s_nop 1
    v_cndmask_b32 v128, v129, v128, vcc
    buffer_load_dwordx4 v[136:139], v128, s[36:39], s63 offen offset:0
    buffer_load_dwordx4 v[140:143], v128, s[36:39], s63 offen offset:16
    s_bitcmp1_b32 s52, 0
    s_cselect_b32 s8, s44, s40
    s_cselect_b32 s9, s45, s41
    s_cselect_b32 s10, s46, s42
    s_mov_b32 s11, 0x00020000
    s_mul_i32 s63, s55, 80
    s_lshr_b32 s67, s52, 1
    s_mul_i32 s67, s67, 20
    s_add_u32 s63, s63, s67
    s_mul_i32 s63, s63, s69
    s_add_u32 s63, s63, s70
    v_lshrrev_b32 v24, 3, v0
    v_mul_lo_u32 v24, v24, s69
    v_and_b32 v25, 7, v0
    v_lshl_add_u32 v24, v25, 4, v24
    s_lshl_b32 s67, s69, 3
    v_cmp_gt_u32 vcc, 32, v0
    v_mov_b32 v26, 0x7f000000
    s_nop 0
    v_cndmask_b32 v26, v26, v24, vcc
    buffer_load_dwordx4 v[144:147], v24, s[8:11], s63 offen
    s_add_u32 s63, s63, s67
    buffer_load_dwordx4 v[148:151], v24, s[8:11], s63 offen
    s_add_u32 s63, s63, s67
    buffer_load_dwordx4 v[152:155], v26, s[8:11], s63 offen
    s_lshl_b32 s63, s53, 6
    s_lshl_b32 s67, s54, 5
    s_add_u32 s63, s63, s67
    v_and_b32 v10, 31, v0
    v_lshrrev_b32 v11, 1, v10
    v_and_b32 v11, 7, v11
    v_lshrrev_b32 v12, 5, v0
    v_add_u32 v10, s63, v10
    v_lshlrev_b32 v10, 7, v10
    v_add_u32 v13, 0, v12
    v_xor_b32 v13, v13, v11
    v_lshl_add_u32 v6, v13, 4, v10
    v_add_u32 v13, 2, v12
    v_xor_b32 v13, v13, v11
    v_lshl_add_u32 v7, v13, 4, v10
    v_add_u32 v13, 4, v12
    v_xor_b32 v13, v13, v11
    v_lshl_add_u32 v8, v13, 4, v10
    v_add_u32 v13, 6, v12
    v_xor_b32 v13, v13, v11
    v_lshl_add_u32 v9, v13, 4, v10
    s_lshl_b32 s67, s54, 13
    s_lshl_b32 s67, s54, 13
    s_sub_u32 s7, 4096, s67
    v_lshrrev_b32 v11, 5, v0
    v_and_b32 v12, 15, v0
    v_lshrrev_b32 v13, 2, v12
    v_and_b32 v12, 3, v12
    v_lshl_add_u32 v14, v11, 3, v13
    v_lshlrev_b32 v14, 7, v14
    v_lshrrev_b32 v15, 4, v0
    v_and_b32 v15, 1, v15
    v_lshlrev_b32 v15, 1, v15
    v_lshrrev_b32 v11, 1, v12
    v_add_u32 v15, v15, v11
    s_lshl_b32 s67, s54, 2
    v_add_u32 v15, s67, v15
    v_lshrrev_b32 v13, 1, v13
    v_lshlrev_b32 v13, 2, v13
    v_xor_b32 v15, v15, v13
    v_lshl_add_u32 v14, v15, 4, v14
    v_and_b32 v12, 1, v12
    v_lshl_add_u32 v14, v12, 3, v14
    v_add_u32 v10, 32768, v14
    v_lshlrev_b32 v2, 2, v0
    s_mov_b32 s27, 19880960
    s_cmp_eq_u32 s52, 0
    s_cselect_b32 s6, 4, 99
    s_cselect_b32 s5, 1, 99
    s_lshl_b32 s58, s54, 1
    s_add_u32 s58, s58, s53
    s_and_b32 s58, s58, 3
    s_mov_b32 s61, 0
    s_barrier
    v_add_u32 v11, s61, v6
    v_add_u32 v56, s7, v11
    v_add_u32 v12, s61, v7
    v_add_u32 v57, s7, v12
    v_add_u32 v13, s61, v8
    v_add_u32 v58, s7, v13
    v_add_u32 v14, s61, v9
    v_add_u32 v59, s7, v14
    v_add_u32 v15, s61, v10
    s_add_u32 s61, s61, 49152
    s_cmp_eq_u32 s61, 147456
    s_cselect_b32 s61, 0, s61
    ds_read_b128 v[24:27], v11
    ds_read_b64_tr_b16 v[40:41], v15 offset:0
    ds_read_b64_tr_b16 v[42:43], v15 offset:512
    ds_read_b128 v[28:31], v56
    ds_read_b64_tr_b16 v[44:45], v15 offset:8192
    ds_read_b64_tr_b16 v[46:47], v15 offset:8704
    s_waitcnt vmcnt(0)
    s_waitcnt lgkmcnt(0)
    v_mfma_f32_32x32x16_bf16 v[64:79], v[40:43], v[24:27], 0
    ds_read_b128 v[32:35], v12
    ds_read_b64_tr_b16 v[48:49], v15 offset:2048
    v_lshlrev_b32 v156, 16, v144
    v_and_b32 v157, 0xffff0000, v144
    v_lshlrev_b32 v158, 16, v145
    v_and_b32 v159, 0xffff0000, v145
    v_lshlrev_b32 v160, 16, v146
    v_mfma_f32_32x32x16_bf16 v[80:95], v[44:47], v[24:27], 0
    ds_read_b64_tr_b16 v[50:51], v15 offset:2560
    ds_read_b128 v[36:39], v57
    v_and_b32 v161, 0xffff0000, v146
    v_lshlrev_b32 v162, 16, v147
    v_and_b32 v163, 0xffff0000, v147
    v_lshlrev_b32 v132, 16, v148
    v_and_b32 v133, 0xffff0000, v148
    v_mfma_f32_32x32x16_bf16 v[96:111], v[40:43], v[28:31], 0
    ds_read_b64_tr_b16 v[52:53], v15 offset:10240
    ds_read_b64_tr_b16 v[54:55], v15 offset:10752
    v_add_f32 v156, v156, v132
    v_add_f32 v157, v157, v133
    v_lshlrev_b32 v134, 16, v149
    v_and_b32 v135, 0xffff0000, v149
    v_add_f32 v158, v158, v134
    v_mfma_f32_32x32x16_bf16 v[112:127], v[44:47], v[28:31], 0
    v_add_f32 v159, v159, v135
    v_lshlrev_b32 v132, 16, v150
    s_waitcnt lgkmcnt(0)
    v_mfma_f32_32x32x16_bf16 v[64:79], v[48:51], v[32:35], v[64:79]
    ds_read_b128 v[24:27], v13
    ds_read_b64_tr_b16 v[40:41], v15 offset:4096
    v_and_b32 v133, 0xffff0000, v150
    v_add_f32 v160, v160, v132
    v_add_f32 v161, v161, v133
    v_lshlrev_b32 v134, 16, v151
    v_and_b32 v135, 0xffff0000, v151
    v_mfma_f32_32x32x16_bf16 v[80:95], v[52:55], v[32:35], v[80:95]
    ds_read_b64_tr_b16 v[42:43], v15 offset:4608
    ds_read_b128 v[28:31], v58
    v_add_f32 v162, v162, v134
    v_add_f32 v163, v163, v135
    v_lshlrev_b32 v132, 16, v152
    v_and_b32 v133, 0xffff0000, v152
    v_add_f32 v156, v156, v132
    v_mfma_f32_32x32x16_bf16 v[96:111], v[48:51], v[36:39], v[96:111]
    ds_read_b64_tr_b16 v[44:45], v15 offset:12288
    ds_read_b64_tr_b16 v[46:47], v15 offset:12800
    v_add_f32 v157, v157, v133
    v_lshlrev_b32 v134, 16, v153
    v_and_b32 v135, 0xffff0000, v153
    v_add_f32 v158, v158, v134
    v_add_f32 v159, v159, v135
    v_mfma_f32_32x32x16_bf16 v[112:127], v[52:55], v[36:39], v[112:127]
    v_lshlrev_b32 v132, 16, v154
    v_and_b32 v133, 0xffff0000, v154
    s_waitcnt lgkmcnt(0)
    v_mfma_f32_32x32x16_bf16 v[64:79], v[40:43], v[24:27], v[64:79]
    ds_read_b128 v[32:35], v14
    ds_read_b64_tr_b16 v[48:49], v15 offset:6144
    v_add_f32 v160, v160, v132
    v_add_f32 v161, v161, v133
    v_lshlrev_b32 v134, 16, v155
    v_and_b32 v135, 0xffff0000, v155
    v_add_f32 v162, v162, v134
    v_mfma_f32_32x32x16_bf16 v[80:95], v[44:47], v[24:27], v[80:95]
    ds_read_b64_tr_b16 v[50:51], v15 offset:6656
    ds_read_b128 v[36:39], v59
    v_add_f32 v163, v163, v135
    v_add_f32_dpp v156, v156, v156 row_ror:8 row_mask:0xf bank_mask:0xf
    v_add_f32_dpp v157, v157, v157 row_ror:8 row_mask:0xf bank_mask:0xf
    v_add_f32_dpp v158, v158, v158 row_ror:8 row_mask:0xf bank_mask:0xf
    v_add_f32_dpp v159, v159, v159 row_ror:8 row_mask:0xf bank_mask:0xf
    v_mfma_f32_32x32x16_bf16 v[96:111], v[40:43], v[28:31], v[96:111]
    ds_read_b64_tr_b16 v[52:53], v15 offset:14336
    ds_read_b64_tr_b16 v[54:55], v15 offset:14848
    v_add_f32_dpp v160, v160, v160 row_ror:8 row_mask:0xf bank_mask:0xf
    v_add_f32_dpp v161, v161, v161 row_ror:8 row_mask:0xf bank_mask:0xf
    v_add_f32_dpp v162, v162, v162 row_ror:8 row_mask:0xf bank_mask:0xf
    v_add_f32_dpp v163, v163, v163 row_ror:8 row_mask:0xf bank_mask:0xf
    v_mov_b32 v144, v156
    v_mfma_f32_32x32x16_bf16 v[112:127], v[44:47], v[28:31], v[112:127]
    v_mov_b32 v145, v157
    v_mov_b32 v146, v158
    s_waitcnt lgkmcnt(0)
    s_barrier
    v_add_u32 v11, s61, v6
    v_add_u32 v56, s7, v11
    v_add_u32 v12, s61, v7
    v_add_u32 v57, s7, v12
    v_add_u32 v13, s61, v8
    v_add_u32 v58, s7, v13
    v_add_u32 v14, s61, v9
    v_add_u32 v59, s7, v14
    v_add_u32 v15, s61, v10
    s_add_u32 s61, s61, 49152
    s_cmp_eq_u32 s61, 147456
    s_cselect_b32 s61, 0, s61
    v_mfma_f32_32x32x16_bf16 v[64:79], v[48:51], v[32:35], v[64:79]
    ds_read_b128 v[24:27], v11
    ds_read_b64_tr_b16 v[40:41], v15 offset:0
    v_mov_b32 v147, v159
    v_mov_b32 v148, v160
    v_mov_b32 v149, v161
    v_mov_b32 v150, v162
    v_mov_b32 v151, v163
    v_mfma_f32_32x32x16_bf16 v[80:95], v[52:55], v[32:35], v[80:95]
    ds_read_b64_tr_b16 v[42:43], v15 offset:512
    ds_read_b128 v[28:31], v56
    v_permlane16_swap_b32 v156, v144
    v_permlane16_swap_b32 v157, v145
    v_permlane16_swap_b32 v158, v146
    v_permlane16_swap_b32 v159, v147
    v_permlane16_swap_b32 v160, v148
    v_mfma_f32_32x32x16_bf16 v[96:111], v[48:51], v[36:39], v[96:111]
    ds_read_b64_tr_b16 v[44:45], v15 offset:8192
    ds_read_b64_tr_b16 v[46:47], v15 offset:8704
    v_permlane16_swap_b32 v161, v149
    v_permlane16_swap_b32 v162, v150
    v_permlane16_swap_b32 v163, v151
    v_add_f32 v156, v156, v144
    v_add_f32 v157, v157, v145
    v_mfma_f32_32x32x16_bf16 v[112:127], v[52:55], v[36:39], v[112:127]
    v_add_f32 v158, v158, v146
    v_add_f32 v159, v159, v147
    s_waitcnt lgkmcnt(0)
    v_mfma_f32_32x32x16_bf16 v[64:79], v[40:43], v[24:27], v[64:79]
    ds_read_b128 v[32:35], v12
    ds_read_b64_tr_b16 v[48:49], v15 offset:2048
    v_add_f32 v160, v160, v148
    v_add_f32 v161, v161, v149
    v_add_f32 v162, v162, v150
    v_add_f32 v163, v163, v151
    v_mov_b32 v144, v156
    v_mfma_f32_32x32x16_bf16 v[80:95], v[44:47], v[24:27], v[80:95]
    ds_read_b64_tr_b16 v[50:51], v15 offset:2560
    ds_read_b128 v[36:39], v57
    v_mov_b32 v145, v157
    v_mov_b32 v146, v158
    v_mov_b32 v147, v159
    v_mov_b32 v148, v160
    v_mov_b32 v149, v161
    v_mfma_f32_32x32x16_bf16 v[96:111], v[40:43], v[28:31], v[96:111]
    ds_read_b64_tr_b16 v[52:53], v15 offset:10240
    ds_read_b64_tr_b16 v[54:55], v15 offset:10752
    v_mov_b32 v150, v162
    v_mov_b32 v151, v163
    v_permlane32_swap_b32 v156, v144
    v_permlane32_swap_b32 v157, v145
    v_permlane32_swap_b32 v158, v146
    v_mfma_f32_32x32x16_bf16 v[112:127], v[44:47], v[28:31], v[112:127]
    v_permlane32_swap_b32 v159, v147
    v_permlane32_swap_b32 v160, v148
    s_waitcnt lgkmcnt(0)
    v_mfma_f32_32x32x16_bf16 v[64:79], v[48:51], v[32:35], v[64:79]
    ds_read_b128 v[24:27], v13
    ds_read_b64_tr_b16 v[40:41], v15 offset:4096
    v_permlane32_swap_b32 v161, v149
    v_permlane32_swap_b32 v162, v150
    v_permlane32_swap_b32 v163, v151
    v_add_f32 v156, v156, v144
    v_add_f32 v157, v157, v145
    v_mfma_f32_32x32x16_bf16 v[80:95], v[52:55], v[32:35], v[80:95]
    ds_read_b64_tr_b16 v[42:43], v15 offset:4608
    ds_read_b128 v[28:31], v58
    v_add_f32 v158, v158, v146
    v_add_f32 v159, v159, v147
    v_add_f32 v160, v160, v148
    v_add_f32 v161, v161, v149
    v_add_f32 v162, v162, v150
    v_mfma_f32_32x32x16_bf16 v[96:111], v[48:51], v[36:39], v[96:111]
    ds_read_b64_tr_b16 v[44:45], v15 offset:12288
    ds_read_b64_tr_b16 v[46:47], v15 offset:12800
    v_add_f32 v163, v163, v151
    s_and_b32 s63, s52, 1
    s_lshl_b32 s63, s63, 10
    s_lshr_b32 s67, s52, 1
    s_lshl_b32 s67, s67, 2
    v_mfma_f32_32x32x16_bf16 v[112:127], v[52:55], v[36:39], v[112:127]
    s_add_u32 s63, s63, s67
    s_add_u32 s63, s63, 147456
    s_waitcnt lgkmcnt(0)
    v_mfma_f32_32x32x16_bf16 v[64:79], v[40:43], v[24:27], v[64:79]
    ds_read_b128 v[32:35], v14
    ds_read_b64_tr_b16 v[48:49], v15 offset:6144
    v_and_b32 v5, 7, v0
    v_lshlrev_b32 v5, 7, v5
    v_add_u32 v5, s63, v5
    v_mfma_f32_32x32x16_bf16 v[80:95], v[44:47], v[24:27], v[80:95]
    ds_read_b64_tr_b16 v[50:51], v15 offset:6656
    ds_read_b128 v[36:39], v59
    ds_write_b32 v5, v156 offset:0
    ds_write_b32 v5, v157 offset:16
    ds_write_b32 v5, v158 offset:32
    v_mfma_f32_32x32x16_bf16 v[96:111], v[40:43], v[28:31], v[96:111]
    ds_read_b64_tr_b16 v[52:53], v15 offset:14336
    ds_read_b64_tr_b16 v[54:55], v15 offset:14848
    ds_write_b32 v5, v159 offset:48
    ds_write_b32 v5, v160 offset:64
    ds_write_b32 v5, v161 offset:80
    v_mfma_f32_32x32x16_bf16 v[112:127], v[44:47], v[28:31], v[112:127]
    ds_write_b32 v5, v162 offset:96
    ds_write_b32 v5, v163 offset:112
    s_waitcnt lgkmcnt(0)
    s_barrier
    s_cmp_ge_u32 s52, 2
    s_cbranch_scc1 K1_CSPUB
    s_lshl_b32 s63, s52, 10
    s_add_u32 s63, s63, 147456
    v_add_u32 v5, s63, v16
    ds_read_b128 v[156:159], v5
    s_lshl_b32 s63, s56, 12
    s_lshl_b32 s67, s52, 11
    s_add_u32 s63, s63, s67
    s_lshl_b32 s67, s55, 2
    s_add_u32 s63, s63, s67
    s_add_u32 s63, s63, 19747840
    v_lshlrev_b32 v5, 5, v0
    s_waitcnt lgkmcnt(0)
    v_add_f32 v156, v156, v157
    v_add_f32 v158, v158, v159
    v_add_f32 v156, v156, v158
    buffer_store_dword v156, v5, s[48:51], s63 offen sc0 sc1
    v_mov_b32 v4, 0
    s_nop 0
    buffer_load_dword v3, v4, s[72:75], 0 offen sc1
K1_CSPUB:
    s_nop 1
    v_add_u32 v11, s61, v6
    v_add_u32 v56, s7, v11
    v_add_u32 v12, s61, v7
    v_add_u32 v57, s7, v12
    v_add_u32 v13, s61, v8
    v_add_u32 v58, s7, v13
    v_add_u32 v14, s61, v9
    v_add_u32 v59, s7, v14
    v_add_u32 v15, s61, v10
    s_add_u32 s61, s61, 49152
    s_cmp_eq_u32 s61, 147456
    s_cselect_b32 s61, 0, s61
    v_mfma_f32_32x32x16_bf16 v[64:79], v[48:51], v[32:35], v[64:79]
    ds_read_b128 v[24:27], v11
    ds_read_b64_tr_b16 v[40:41], v15 offset:0
    v_mfma_f32_32x32x16_bf16 v[80:95], v[52:55], v[32:35], v[80:95]
    ds_read_b64_tr_b16 v[42:43], v15 offset:512
    ds_read_b128 v[28:31], v56
    v_mfma_f32_32x32x16_bf16 v[96:111], v[48:51], v[36:39], v[96:111]
    ds_read_b64_tr_b16 v[44:45], v15 offset:8192
    ds_read_b64_tr_b16 v[46:47], v15 offset:8704
    v_mfma_f32_32x32x16_bf16 v[112:127], v[52:55], v[36:39], v[112:127]
    s_waitcnt lgkmcnt(0)
    v_mfma_f32_32x32x16_bf16 v[64:79], v[40:43], v[24:27], v[64:79]
    ds_read_b128 v[32:35], v12
    ds_read_b64_tr_b16 v[48:49], v15 offset:2048
    v_lshlrev_b32 v128, 16, v136
    v_and_b32 v129, 0xffff0000, v136
    v_add_f32 v17, v17, v128
    v_add_f32 v18, v18, v129
    v_fmac_f32 v19, v128, v128
    v_mfma_f32_32x32x16_bf16 v[80:95], v[44:47], v[24:27], v[80:95]
    ds_read_b64_tr_b16 v[50:51], v15 offset:2560
    ds_read_b128 v[36:39], v57
    v_fmac_f32 v20, v129, v129
    v_lshlrev_b32 v130, 16, v137
    v_and_b32 v131, 0xffff0000, v137
    v_add_f32 v17, v17, v130
    v_add_f32 v18, v18, v131
    v_mfma_f32_32x32x16_bf16 v[96:111], v[40:43], v[28:31], v[96:111]
    ds_read_b64_tr_b16 v[52:53], v15 offset:10240
    ds_read_b64_tr_b16 v[54:55], v15 offset:10752
    v_fmac_f32 v19, v130, v130
    v_fmac_f32 v20, v131, v131
    v_lshlrev_b32 v128, 16, v138
    v_and_b32 v129, 0xffff0000, v138
    v_add_f32 v17, v17, v128
    v_mfma_f32_32x32x16_bf16 v[112:127], v[44:47], v[28:31], v[112:127]
    v_add_f32 v18, v18, v129
    v_fmac_f32 v19, v128, v128
    v_fmac_f32 v20, v129, v129
    v_lshlrev_b32 v130, 16, v139
    v_and_b32 v131, 0xffff0000, v139
    s_waitcnt lgkmcnt(0)
    v_mfma_f32_32x32x16_bf16 v[64:79], v[48:51], v[32:35], v[64:79]
    ds_read_b128 v[24:27], v13
    ds_read_b64_tr_b16 v[40:41], v15 offset:4096
    v_add_f32 v17, v17, v130
    v_add_f32 v18, v18, v131
    v_fmac_f32 v19, v130, v130
    v_fmac_f32 v20, v131, v131
    v_lshlrev_b32 v128, 16, v140
    v_mfma_f32_32x32x16_bf16 v[80:95], v[52:55], v[32:35], v[80:95]
    ds_read_b64_tr_b16 v[42:43], v15 offset:4608
    ds_read_b128 v[28:31], v58
    v_and_b32 v129, 0xffff0000, v140
    v_add_f32 v17, v17, v128
    v_add_f32 v18, v18, v129
    v_fmac_f32 v19, v128, v128
    v_fmac_f32 v20, v129, v129
    v_mfma_f32_32x32x16_bf16 v[96:111], v[48:51], v[36:39], v[96:111]
    ds_read_b64_tr_b16 v[44:45], v15 offset:12288
    ds_read_b64_tr_b16 v[46:47], v15 offset:12800
    v_lshlrev_b32 v130, 16, v141
    v_and_b32 v131, 0xffff0000, v141
    v_add_f32 v17, v17, v130
    v_add_f32 v18, v18, v131
    v_fmac_f32 v19, v130, v130
    v_mfma_f32_32x32x16_bf16 v[112:127], v[52:55], v[36:39], v[112:127]
    v_fmac_f32 v20, v131, v131
    v_lshlrev_b32 v128, 16, v142
    v_and_b32 v129, 0xffff0000, v142
    v_add_f32 v17, v17, v128
    v_add_f32 v18, v18, v129
    s_waitcnt lgkmcnt(0)
    v_mfma_f32_32x32x16_bf16 v[64:79], v[40:43], v[24:27], v[64:79]
    ds_read_b128 v[32:35], v14
    ds_read_b64_tr_b16 v[48:49], v15 offset:6144
    v_fmac_f32 v19, v128, v128
    v_fmac_f32 v20, v129, v129
    v_lshlrev_b32 v130, 16, v143
    v_and_b32 v131, 0xffff0000, v143
    v_add_f32 v17, v17, v130
    v_mfma_f32_32x32x16_bf16 v[80:95], v[44:47], v[24:27], v[80:95]
    ds_read_b64_tr_b16 v[50:51], v15 offset:6656
    ds_read_b128 v[36:39], v59
    v_add_f32 v18, v18, v131
    v_fmac_f32 v19, v130, v130
    v_fmac_f32 v20, v131, v131
    v_add_f32 v17, v17, v18
    v_add_f32 v19, v19, v20
    v_mfma_f32_32x32x16_bf16 v[96:111], v[40:43], v[28:31], v[96:111]
    ds_read_b64_tr_b16 v[52:53], v15 offset:14336
    ds_read_b64_tr_b16 v[54:55], v15 offset:14848
    v_add_f32_dpp v17, v17, v17 row_ror:8 row_mask:0xf bank_mask:0xf
    v_add_f32_dpp v19, v19, v19 row_ror:8 row_mask:0xf bank_mask:0xf
    s_nop 0
    v_add_f32_dpp v17, v17, v17 row_ror:4 row_mask:0xf bank_mask:0xf
    v_add_f32_dpp v19, v19, v19 row_ror:4 row_mask:0xf bank_mask:0xf
    s_nop 0
    v_add_f32_dpp v17, v17, v17 row_ror:2 row_mask:0xf bank_mask:0xf
    v_mfma_f32_32x32x16_bf16 v[112:127], v[44:47], v[28:31], v[112:127]
    v_add_f32_dpp v19, v19, v19 row_ror:2 row_mask:0xf bank_mask:0xf
    v_add_f32_dpp v17, v17, v17 row_ror:1 row_mask:0xf bank_mask:0xf
    s_nop 0
    v_add_f32_dpp v19, v19, v19 row_ror:1 row_mask:0xf bank_mask:0xf
    v_add_f32_dpp v17, v17, v17 row_bcast:15 row_mask:0xa bank_mask:0xf
    s_nop 0
    v_add_f32_dpp v19, v19, v19 row_bcast:15 row_mask:0xa bank_mask:0xf
    s_waitcnt lgkmcnt(0)
    s_barrier
    v_add_u32 v11, s61, v6
    v_add_u32 v56, s7, v11
    v_add_u32 v12, s61, v7
    v_add_u32 v57, s7, v12
    v_add_u32 v13, s61, v8
    v_add_u32 v58, s7, v13
    v_add_u32 v14, s61, v9
    v_add_u32 v59, s7, v14
    v_add_u32 v15, s61, v10
    s_add_u32 s61, s61, 49152
    s_cmp_eq_u32 s61, 147456
    s_cselect_b32 s61, 0, s61
    v_mfma_f32_32x32x16_bf16 v[64:79], v[48:51], v[32:35], v[64:79]
    ds_read_b128 v[24:27], v11
    ds_read_b64_tr_b16 v[40:41], v15 offset:0
    v_add_f32_dpp v17, v17, v17 row_bcast:31 row_mask:0xc bank_mask:0xf
    v_add_f32_dpp v19, v19, v19 row_bcast:31 row_mask:0xc bank_mask:0xf
    v_mul_f32 v17, 0x3acccccd, v17
    v_mul_f32 v19, 0x3acccccd, v19
    v_fma_f32 v19, -v17, v17, v19
    v_mfma_f32_32x32x16_bf16 v[80:95], v[52:55], v[32:35], v[80:95]
    ds_read_b64_tr_b16 v[42:43], v15 offset:512
    ds_read_b128 v[28:31], v56
    v_max_f32 v19, 0, v19
    v_cvt_pk_bf16_f32 v128, v17, v17
    v_xor_b32 v128, 0x80008000, v128
    v_cvt_pk_bf16_f32 v19, v19, v19
    v_lshlrev_b32 v19, 16, v19
    v_mfma_f32_32x32x16_bf16 v[96:111], v[48:51], v[36:39], v[96:111]
    ds_read_b64_tr_b16 v[44:45], v15 offset:8192
    ds_read_b64_tr_b16 v[46:47], v15 offset:8704
    v_add_f32 v19, 0x3727c5ac, v19
    v_cvt_pk_bf16_f32 v19, v19, v19
    v_lshlrev_b32 v19, 16, v19
    v_sqrt_f32 v19, v19
    s_nop 0
    v_cvt_pk_bf16_f32 v19, v19, v19
    v_mfma_f32_32x32x16_bf16 v[112:127], v[52:55], v[36:39], v[112:127]
    v_lshlrev_b32 v19, 16, v19
    v_rcp_f32 v129, v19
    v_lshlrev_b32 v23, 3, v23
    v_cmp_eq_u32 vcc, 63, v0
    s_nop 0
    s_and_saveexec_b64 s[78:79], vcc
    buffer_store_dwordx2 v[128:129], v23, s[48:51], s76 offen sc0 sc1
    s_mov_b64 exec, s[78:79]
    s_mov_b32 s62, 4
K1_LOOP:
    s_waitcnt lgkmcnt(0)
    v_mfma_f32_32x32x16_bf16 v[64:79], v[40:43], v[24:27], v[64:79]
    ds_read_b128 v[32:35], v12
    ds_read_b64_tr_b16 v[48:49], v15 offset:2048
    v_mfma_f32_32x32x16_bf16 v[80:95], v[44:47], v[24:27], v[80:95]
    ds_read_b64_tr_b16 v[50:51], v15 offset:2560
    ds_read_b128 v[36:39], v57
    v_mfma_f32_32x32x16_bf16 v[96:111], v[40:43], v[28:31], v[96:111]
    ds_read_b64_tr_b16 v[52:53], v15 offset:10240
    ds_read_b64_tr_b16 v[54:55], v15 offset:10752
    v_mfma_f32_32x32x16_bf16 v[112:127], v[44:47], v[28:31], v[112:127]
    s_waitcnt lgkmcnt(0)
    v_mfma_f32_32x32x16_bf16 v[64:79], v[48:51], v[32:35], v[64:79]
    ds_read_b128 v[24:27], v13
    ds_read_b64_tr_b16 v[40:41], v15 offset:4096
    v_mfma_f32_32x32x16_bf16 v[80:95], v[52:55], v[32:35], v[80:95]
    ds_read_b64_tr_b16 v[42:43], v15 offset:4608
    ds_read_b128 v[28:31], v58
    v_mfma_f32_32x32x16_bf16 v[96:111], v[48:51], v[36:39], v[96:111]
    ds_read_b64_tr_b16 v[44:45], v15 offset:12288
    ds_read_b64_tr_b16 v[46:47], v15 offset:12800
    v_mfma_f32_32x32x16_bf16 v[112:127], v[52:55], v[36:39], v[112:127]
    s_waitcnt lgkmcnt(0)
    v_mfma_f32_32x32x16_bf16 v[64:79], v[40:43], v[24:27], v[64:79]
    ds_read_b128 v[32:35], v14
    ds_read_b64_tr_b16 v[48:49], v15 offset:6144
    v_mfma_f32_32x32x16_bf16 v[80:95], v[44:47], v[24:27], v[80:95]
    ds_read_b64_tr_b16 v[50:51], v15 offset:6656
    ds_read_b128 v[36:39], v59
    v_mfma_f32_32x32x16_bf16 v[96:111], v[40:43], v[28:31], v[96:111]
    ds_read_b64_tr_b16 v[52:53], v15 offset:14336
    ds_read_b64_tr_b16 v[54:55], v15 offset:14848
    v_mfma_f32_32x32x16_bf16 v[112:127], v[44:47], v[28:31], v[112:127]
    s_waitcnt lgkmcnt(0)
    s_waitcnt vmcnt(0)
    s_barrier
    s_cmp_eq_u32 s62, s6
    s_cbranch_scc0 K1_SG2
    v_readfirstlane_b32 s3, v3
    v_mov_b32 v135, 0
    s_nop 3
    s_cmp_lg_u32 s3, 0
    s_cbranch_scc1 K1_NC2_OK
    v_mov_b32 v135, 0
K1_NC2:
    buffer_load_dword v134, v135, s[72:75], 0 offen sc1
    s_waitcnt vmcnt(0)
    v_readfirstlane_b32 s3, v134
    s_nop 3
    s_cmp_lg_u32 s3, 0
    s_cbranch_scc1 K1_NC2_OK
    s_sleep 2
    s_branch K1_NC2
K1_NC2_OK:
    s_mov_b64 exec, 1
    v_mov_b32 v134, s3
    s_lshl_b32 s63, s2, 2
    s_add_u32 s63, s63, 19880960
    s_nop 1
    buffer_store_dword v134, v135, s[48:51], s63 offen sc0 sc1
    v_mov_b32 v135, 163328
    s_nop 0
    ds_write_b32 v135, v134 offset:4
    s_mov_b64 exec, -1
K1_SG2:
    s_cmp_eq_u32 s62, s5
    s_cbranch_scc0 K1_PL2
    buffer_load_dwordx4 v[160:163], v16, s[48:51], s27 offen sc1
K1_PL2:
    v_add_u32 v11, s61, v6
    v_add_u32 v56, s7, v11
    v_add_u32 v12, s61, v7
    v_add_u32 v57, s7, v12
    v_add_u32 v13, s61, v8
    v_add_u32 v58, s7, v13
    v_add_u32 v14, s61, v9
    v_add_u32 v59, s7, v14
    v_add_u32 v15, s61, v10
    s_add_u32 s61, s61, 49152
    s_cmp_eq_u32 s61, 147456
    s_cselect_b32 s61, 0, s61
    v_mfma_f32_32x32x16_bf16 v[64:79], v[48:51], v[32:35], v[64:79]
    ds_read_b128 v[24:27], v11
    ds_read_b64_tr_b16 v[40:41], v15 offset:0
    v_mfma_f32_32x32x16_bf16 v[80:95], v[52:55], v[32:35], v[80:95]
    ds_read_b64_tr_b16 v[42:43], v15 offset:512
    ds_read_b128 v[28:31], v56
    v_mfma_f32_32x32x16_bf16 v[96:111], v[48:51], v[36:39], v[96:111]
    ds_read_b64_tr_b16 v[44:45], v15 offset:8192
    ds_read_b64_tr_b16 v[46:47], v15 offset:8704
    v_mfma_f32_32x32x16_bf16 v[112:127], v[52:55], v[36:39], v[112:127]
    s_sub_u32 s62, s62, 1
    s_cmp_lg_u32 s62, 0
    s_cbranch_scc1 K1_LOOP
    s_waitcnt lgkmcnt(0)
    v_mfma_f32_32x32x16_bf16 v[64:79], v[40:43], v[24:27], v[64:79]
    ds_read_b128 v[32:35], v12
    ds_read_b64_tr_b16 v[48:49], v15 offset:2048
    v_mfma_f32_32x32x16_bf16 v[80:95], v[44:47], v[24:27], v[80:95]
    ds_read_b64_tr_b16 v[50:51], v15 offset:2560
    ds_read_b128 v[36:39], v57
    v_mfma_f32_32x32x16_bf16 v[96:111], v[40:43], v[28:31], v[96:111]
    ds_read_b64_tr_b16 v[52:53], v15 offset:10240
    ds_read_b64_tr_b16 v[54:55], v15 offset:10752
    v_mfma_f32_32x32x16_bf16 v[112:127], v[44:47], v[28:31], v[112:127]
    s_waitcnt lgkmcnt(0)
    v_mfma_f32_32x32x16_bf16 v[64:79], v[48:51], v[32:35], v[64:79]
    ds_read_b128 v[24:27], v13
    ds_read_b64_tr_b16 v[40:41], v15 offset:4096
    v_mfma_f32_32x32x16_bf16 v[80:95], v[52:55], v[32:35], v[80:95]
    ds_read_b64_tr_b16 v[42:43], v15 offset:4608
    ds_read_b128 v[28:31], v58
    v_mfma_f32_32x32x16_bf16 v[96:111], v[48:51], v[36:39], v[96:111]
    ds_read_b64_tr_b16 v[44:45], v15 offset:12288
    ds_read_b64_tr_b16 v[46:47], v15 offset:12800
    v_mfma_f32_32x32x16_bf16 v[112:127], v[52:55], v[36:39], v[112:127]
    s_waitcnt lgkmcnt(0)
    v_mfma_f32_32x32x16_bf16 v[64:79], v[40:43], v[24:27], v[64:79]
    ds_read_b128 v[32:35], v14
    ds_read_b64_tr_b16 v[48:49], v15 offset:6144
    v_mfma_f32_32x32x16_bf16 v[80:95], v[44:47], v[24:27], v[80:95]
    ds_read_b64_tr_b16 v[50:51], v15 offset:6656
    ds_read_b128 v[36:39], v59
    v_mfma_f32_32x32x16_bf16 v[96:111], v[40:43], v[28:31], v[96:111]
    ds_read_b64_tr_b16 v[52:53], v15 offset:14336
    ds_read_b64_tr_b16 v[54:55], v15 offset:14848
    v_mfma_f32_32x32x16_bf16 v[112:127], v[44:47], v[28:31], v[112:127]
    s_waitcnt lgkmcnt(0)
    s_cmp_lg_u32 s52, 0
    s_cbranch_scc1 K1_POLLOK
K1_POLL:
    s_waitcnt vmcnt(0)
    v_xor_b32 v160, s3, v160
    v_xor_b32 v161, s3, v161
    v_xor_b32 v162, s3, v162
    v_xor_b32 v163, s3, v163
    v_or3_b32 v160, v160, v161, v162
    v_or_b32 v160, v160, v163
    v_cmp_eq_u32 vcc, 0, v160
    s_nop 3
    s_cmp_eq_u64 vcc, exec
    s_cbranch_scc1 K1_POLLOK
    s_sleep 2
    buffer_load_dwordx4 v[160:163], v16, s[48:51], s27 offen sc1
    s_branch K1_POLL
K1_POLLOK:
    s_barrier
    v_add_u32 v11, s61, v6
    v_add_u32 v56, s7, v11
    v_add_u32 v12, s61, v7
    v_add_u32 v57, s7, v12
    v_add_u32 v13, s61, v8
    v_add_u32 v58, s7, v13
    v_add_u32 v14, s61, v9
    v_add_u32 v59, s7, v14
    v_add_u32 v15, s61, v10
    s_add_u32 s61, s61, 49152
    s_cmp_eq_u32 s61, 147456
    s_cselect_b32 s61, 0, s61
    v_and_b32 v128, 31, v0
    s_lshl_b32 s63, s55, 8
    s_lshl_b32 s67, s53, 6
    s_add_u32 s63, s63, s67
    s_lshl_b32 s67, s54, 5
    s_add_u32 s63, s63, s67
    v_add_u32 v128, s63, v128
    v_lshlrev_b32 v128, 3, v128
    v_xor_b32 v129, 256, v128
    buffer_load_dwordx2 v[60:61], v128, s[48:51], s76 offen sc1
    buffer_load_dwordx2 v[62:63], v129, s[48:51], s76 offen sc1
    v_and_b32 v128, 31, v0
    v_lshlrev_b32 v128, 5, v128
    s_lshl_b32 s63, s56, 12
    s_lshl_b32 s67, s54, 10
    s_add_u32 s63, s63, s67
    s_add_u32 s63, s63, 19747840
    buffer_load_dwordx4 v[136:139], v128, s[48:51], s63 offen offset:0 sc1
    buffer_load_dwordx4 v[140:143], v128, s[48:51], s63 offen offset:16 sc1
    buffer_load_dwordx4 v[152:155], v128, s[48:51], s63 offen offset:2048 sc1
    buffer_load_dwordx4 v[156:159], v128, s[48:51], s63 offen offset:2064 sc1
    v_mfma_f32_32x32x16_bf16 v[64:79], v[48:51], v[32:35], v[64:79]
    ds_read_b128 v[24:27], v11
    ds_read_b64_tr_b16 v[40:41], v15 offset:0
    v_mfma_f32_32x32x16_bf16 v[80:95], v[52:55], v[32:35], v[80:95]
    ds_read_b64_tr_b16 v[42:43], v15 offset:512
    ds_read_b128 v[28:31], v56
    v_mfma_f32_32x32x16_bf16 v[96:111], v[48:51], v[36:39], v[96:111]
    ds_read_b64_tr_b16 v[44:45], v15 offset:8192
    ds_read_b64_tr_b16 v[46:47], v15 offset:8704
    v_mfma_f32_32x32x16_bf16 v[112:127], v[52:55], v[36:39], v[112:127]
    s_waitcnt lgkmcnt(0)
    v_mfma_f32_32x32x16_bf16 v[64:79], v[40:43], v[24:27], v[64:79]
    ds_read_b128 v[32:35], v12
    ds_read_b64_tr_b16 v[48:49], v15 offset:2048
    v_mfma_f32_32x32x16_bf16 v[80:95], v[44:47], v[24:27], v[80:95]
    ds_read_b64_tr_b16 v[50:51], v15 offset:2560
    ds_read_b128 v[36:39], v57
    v_mfma_f32_32x32x16_bf16 v[96:111], v[40:43], v[28:31], v[96:111]
    ds_read_b64_tr_b16 v[52:53], v15 offset:10240
    ds_read_b64_tr_b16 v[54:55], v15 offset:10752
    v_mfma_f32_32x32x16_bf16 v[112:127], v[44:47], v[28:31], v[112:127]
    s_waitcnt lgkmcnt(0)
    v_mfma_f32_32x32x16_bf16 v[64:79], v[48:51], v[32:35], v[64:79]
    ds_read_b128 v[24:27], v13
    ds_read_b64_tr_b16 v[40:41], v15 offset:4096
    v_mfma_f32_32x32x16_bf16 v[80:95], v[52:55], v[32:35], v[80:95]
    ds_read_b64_tr_b16 v[42:43], v15 offset:4608
    ds_read_b128 v[28:31], v58
    v_mfma_f32_32x32x16_bf16 v[96:111], v[48:51], v[36:39], v[96:111]
    ds_read_b64_tr_b16 v[44:45], v15 offset:12288
    ds_read_b64_tr_b16 v[46:47], v15 offset:12800
    v_mfma_f32_32x32x16_bf16 v[112:127], v[52:55], v[36:39], v[112:127]
    s_waitcnt lgkmcnt(0)
    v_mfma_f32_32x32x16_bf16 v[64:79], v[40:43], v[24:27], v[64:79]
    ds_read_b128 v[32:35], v14
    ds_read_b64_tr_b16 v[48:49], v15 offset:6144
    v_mfma_f32_32x32x16_bf16 v[80:95], v[44:47], v[24:27], v[80:95]
    ds_read_b64_tr_b16 v[50:51], v15 offset:6656
    ds_read_b128 v[36:39], v59
    v_mfma_f32_32x32x16_bf16 v[96:111], v[40:43], v[28:31], v[96:111]
    ds_read_b64_tr_b16 v[52:53], v15 offset:14336
    ds_read_b64_tr_b16 v[54:55], v15 offset:14848
    v_mfma_f32_32x32x16_bf16 v[112:127], v[44:47], v[28:31], v[112:127]
    s_waitcnt lgkmcnt(0)
    s_barrier
    v_add_u32 v11, s61, v6
    v_add_u32 v56, s7, v11
    v_add_u32 v12, s61, v7
    v_add_u32 v57, s7, v12
    v_add_u32 v13, s61, v8
    v_add_u32 v58, s7, v13
    v_add_u32 v14, s61, v9
    v_add_u32 v59, s7, v14
    v_add_u32 v15, s61, v10
    s_add_u32 s61, s61, 49152
    s_cmp_eq_u32 s61, 147456
    s_cselect_b32 s61, 0, s61
    v_mfma_f32_32x32x16_bf16 v[64:79], v[48:51], v[32:35], v[64:79]
    ds_read_b128 v[24:27], v11
    ds_read_b64_tr_b16 v[40:41], v15 offset:0
    v_mfma_f32_32x32x16_bf16 v[80:95], v[52:55], v[32:35], v[80:95]
    ds_read_b64_tr_b16 v[42:43], v15 offset:512
    ds_read_b128 v[28:31], v56
    v_mfma_f32_32x32x16_bf16 v[96:111], v[48:51], v[36:39], v[96:111]
    ds_read_b64_tr_b16 v[44:45], v15 offset:8192
    ds_read_b64_tr_b16 v[46:47], v15 offset:8704
    v_mfma_f32_32x32x16_bf16 v[112:127], v[52:55], v[36:39], v[112:127]
    s_waitcnt lgkmcnt(0)
    s_waitcnt vmcnt(0)
    v_mfma_f32_32x32x16_bf16 v[64:79], v[40:43], v[24:27], v[64:79]
    ds_read_b128 v[32:35], v12
    ds_read_b64_tr_b16 v[48:49], v15 offset:2048
    v_add_f32 v136, v136, v137
    v_add_f32 v138, v138, v139
    v_add_f32 v140, v140, v141
    v_mfma_f32_32x32x16_bf16 v[80:95], v[44:47], v[24:27], v[80:95]
    ds_read_b64_tr_b16 v[50:51], v15 offset:2560
    ds_read_b128 v[36:39], v57
    v_add_f32 v142, v142, v143
    v_add_f32 v136, v136, v138
    v_add_f32 v140, v140, v142
    v_mfma_f32_32x32x16_bf16 v[96:111], v[40:43], v[28:31], v[96:111]
    ds_read_b64_tr_b16 v[52:53], v15 offset:10240
    ds_read_b64_tr_b16 v[54:55], v15 offset:10752
    v_add_f32 v136, v136, v140
    v_cvt_pk_bf16_f32 v137, v136, v136
    v_lshlrev_b32 v138, 16, v137
    v_mfma_f32_32x32x16_bf16 v[112:127], v[44:47], v[28:31], v[112:127]
    v_sub_f32 v136, v136, v138
    v_cvt_pk_bf16_f32 v140, v136, v136
    v_lshlrev_b32 v138, 16, v140
    s_waitcnt lgkmcnt(0)
    v_mfma_f32_32x32x16_bf16 v[64:79], v[48:51], v[32:35], v[64:79]
    ds_read_b128 v[24:27], v13
    ds_read_b64_tr_b16 v[40:41], v15 offset:4096
    v_sub_f32 v136, v136, v138
    v_and_b32 v137, 0xffff, v137
    v_or_b32 v140, v137, v138
    v_mfma_f32_32x32x16_bf16 v[80:95], v[52:55], v[32:35], v[80:95]
    ds_read_b64_tr_b16 v[42:43], v15 offset:4608
    ds_read_b128 v[28:31], v58
    v_cvt_pk_bf16_f32 v141, v136, 0
    v_mov_b32 v142, 0
    v_mov_b32 v143, 0
    v_mfma_f32_32x32x16_bf16 v[96:111], v[48:51], v[36:39], v[96:111]
    ds_read_b64_tr_b16 v[44:45], v15 offset:12288
    ds_read_b64_tr_b16 v[46:47], v15 offset:12800
    v_add_f32 v152, v152, v153
    v_add_f32 v154, v154, v155
    v_add_f32 v156, v156, v157
    v_mfma_f32_32x32x16_bf16 v[112:127], v[52:55], v[36:39], v[112:127]
    v_add_f32 v158, v158, v159
    v_add_f32 v152, v152, v154
    v_add_f32 v156, v156, v158
    s_waitcnt lgkmcnt(0)
    v_mfma_f32_32x32x16_bf16 v[64:79], v[40:43], v[24:27], v[64:79]
    ds_read_b128 v[32:35], v14
    ds_read_b64_tr_b16 v[48:49], v15 offset:6144
    v_add_f32 v152, v152, v156
    v_cvt_pk_bf16_f32 v153, v152, v152
    v_lshlrev_b32 v154, 16, v153
    v_mfma_f32_32x32x16_bf16 v[80:95], v[44:47], v[24:27], v[80:95]
    ds_read_b64_tr_b16 v[50:51], v15 offset:6656
    ds_read_b128 v[36:39], v59
    v_sub_f32 v152, v152, v154
    v_cvt_pk_bf16_f32 v156, v152, v152
    v_lshlrev_b32 v154, 16, v156
    v_mfma_f32_32x32x16_bf16 v[96:111], v[40:43], v[28:31], v[96:111]
    ds_read_b64_tr_b16 v[52:53], v15 offset:14336
    ds_read_b64_tr_b16 v[54:55], v15 offset:14848
    v_sub_f32 v152, v152, v154
    v_and_b32 v153, 0xffff, v153
    v_or_b32 v156, v153, v154
    v_mfma_f32_32x32x16_bf16 v[112:127], v[44:47], v[28:31], v[112:127]
    v_cvt_pk_bf16_f32 v157, v152, 0
    v_mov_b32 v158, 0
    v_mov_b32 v159, 0
    s_waitcnt lgkmcnt(0)
    s_barrier
    v_mfma_f32_32x32x16_bf16 v[64:79], v[48:51], v[32:35], v[64:79]
    s_waitcnt vmcnt(0)
    v_cmp_gt_u32 vcc, 32, v0
    s_nop 1
    v_cndmask_b32 v8, 0, v60, vcc
    v_and_b32 v9, 0xffff, v8
    v_mfma_f32_32x32x16_bf16 v[80:95], v[52:55], v[32:35], v[80:95]
    v_mov_b32 v10, 0
    v_mov_b32 v11, 0
    v_mfma_f32_32x32x16_bf16 v[96:111], v[48:51], v[36:39], v[96:111]
    v_cndmask_b32 v12, 0, v62, vcc
    v_and_b32 v13, 0xffff, v12
    v_mfma_f32_32x32x16_bf16 v[112:127], v[52:55], v[36:39], v[112:127]
    v_mov_b32 v14, 0
    v_mov_b32 v15, 0
    v_mfma_f32_32x32x16_bf16 v[64:79], v[140:143], v[8:11], v[64:79]
    v_mfma_f32_32x32x16_bf16 v[80:95], v[156:159], v[8:11], v[80:95]
    v_mfma_f32_32x32x16_bf16 v[96:111], v[140:143], v[12:15], v[96:111]
    v_mfma_f32_32x32x16_bf16 v[112:127], v[156:159], v[12:15], v[112:127]
    s_lshl_b32 s4, s55, 3
    s_lshl_b32 s63, s53, 1
    s_add_u32 s4, s4, s63
    s_add_u32 s4, s4, s54
    s_xor_b32 s5, s4, 1
    s_cmp_ge_u32 s56, 24
    s_cbranch_scc1 K1_QEPI
    s_lshl_b32 s63, s56, 1
    s_add_u32 s63, s63, s54
    s_lshl_b32 s63, s63, 11
    s_add_u32 s63, s63, 2621440
    s_mul_i32 s8, s4, 98304
    s_add_u32 s8, s8, s63
    s_mul_i32 s9, s5, 98304
    s_add_u32 s9, s9, s63
    v_mul_f32 v24, 0xbfb8aa3b, v61
    v_mul_f32 v25, v61, v61
    v_mul_f32 v28, v24, v64
    v_mul_f32 v29, v24, v65
    v_mul_f32 v30, v24, v66
    v_mul_f32 v31, v24, v67
    v_mul_f32 v32, v24, v68
    v_mul_f32 v33, v24, v69
    v_mul_f32 v34, v24, v70
    v_mul_f32 v35, v24, v71
    v_exp_f32 v28, v28
    v_exp_f32 v29, v29
    v_exp_f32 v30, v30
    v_exp_f32 v31, v31
    v_exp_f32 v32, v32
    v_exp_f32 v33, v33
    v_exp_f32 v34, v34
    v_exp_f32 v35, v35
    v_mul_f32 v64, v64, v80
    v_mul_f32 v65, v65, v81
    v_mul_f32 v66, v66, v82
    v_mul_f32 v67, v67, v83
    v_mul_f32 v68, v68, v84
    v_mul_f32 v69, v69, v85
    v_mul_f32 v70, v70, v86
    v_mul_f32 v71, v71, v87
    v_add_f32 v28, 1.0, v28
    v_add_f32 v29, 1.0, v29
    v_add_f32 v30, 1.0, v30
    v_add_f32 v31, 1.0, v31
    v_add_f32 v32, 1.0, v32
    v_add_f32 v33, 1.0, v33
    v_add_f32 v34, 1.0, v34
    v_add_f32 v35, 1.0, v35
    v_rcp_f32 v28, v28
    v_rcp_f32 v29, v29
    v_rcp_f32 v30, v30
    v_rcp_f32 v31, v31
    v_rcp_f32 v32, v32
    v_rcp_f32 v33, v33
    v_rcp_f32 v34, v34
    v_rcp_f32 v35, v35
    v_mul_f32 v64, v25, v64
    v_mul_f32 v65, v25, v65
    v_mul_f32 v66, v25, v66
    v_mul_f32 v67, v25, v67
    v_mul_f32 v68, v25, v68
    v_mul_f32 v69, v25, v69
    v_mul_f32 v70, v25, v70
    v_mul_f32 v71, v25, v71
    v_mul_f32 v64, v64, v28
    v_mul_f32 v65, v65, v29
    v_mul_f32 v66, v66, v30
    v_mul_f32 v67, v67, v31
    v_mul_f32 v68, v68, v32
    v_mul_f32 v69, v69, v33
    v_mul_f32 v70, v70, v34
    v_mul_f32 v71, v71, v35
    v_cvt_pk_bf16_f32 v36, v64, v65
    v_cvt_pk_bf16_f32 v37, v66, v67
    v_cvt_pk_bf16_f32 v38, v68, v69
    v_cvt_pk_bf16_f32 v39, v70, v71
    buffer_store_dwordx4 v[36:39], v16, s[48:51], s8 offen offset:0 sc0 sc1
    v_mul_f32 v28, v24, v72
    v_mul_f32 v29, v24, v73
    v_mul_f32 v30, v24, v74
    v_mul_f32 v31, v24, v75
    v_mul_f32 v32, v24, v76
    v_mul_f32 v33, v24, v77
    v_mul_f32 v34, v24, v78
    v_mul_f32 v35, v24, v79
    v_exp_f32 v28, v28
    v_exp_f32 v29, v29
    v_exp_f32 v30, v30
    v_exp_f32 v31, v31
    v_exp_f32 v32, v32
    v_exp_f32 v33, v33
    v_exp_f32 v34, v34
    v_exp_f32 v35, v35
    v_mul_f32 v72, v72, v88
    v_mul_f32 v73, v73, v89
    v_mul_f32 v74, v74, v90
    v_mul_f32 v75, v75, v91
    v_mul_f32 v76, v76, v92
    v_mul_f32 v77, v77, v93
    v_mul_f32 v78, v78, v94
    v_mul_f32 v79, v79, v95
    v_add_f32 v28, 1.0, v28
    v_add_f32 v29, 1.0, v29
    v_add_f32 v30, 1.0, v30
    v_add_f32 v31, 1.0, v31
    v_add_f32 v32, 1.0, v32
    v_add_f32 v33, 1.0, v33
    v_add_f32 v34, 1.0, v34
    v_add_f32 v35, 1.0, v35
    v_rcp_f32 v28, v28
    v_rcp_f32 v29, v29
    v_rcp_f32 v30, v30
    v_rcp_f32 v31, v31
    v_rcp_f32 v32, v32
    v_rcp_f32 v33, v33
    v_rcp_f32 v34, v34
    v_rcp_f32 v35, v35
    v_mul_f32 v72, v25, v72
    v_mul_f32 v73, v25, v73
    v_mul_f32 v74, v25, v74
    v_mul_f32 v75, v25, v75
    v_mul_f32 v76, v25, v76
    v_mul_f32 v77, v25, v77
    v_mul_f32 v78, v25, v78
    v_mul_f32 v79, v25, v79
    v_mul_f32 v72, v72, v28
    v_mul_f32 v73, v73, v29
    v_mul_f32 v74, v74, v30
    v_mul_f32 v75, v75, v31
    v_mul_f32 v76, v76, v32
    v_mul_f32 v77, v77, v33
    v_mul_f32 v78, v78, v34
    v_mul_f32 v79, v79, v35
    v_cvt_pk_bf16_f32 v40, v72, v73
    v_cvt_pk_bf16_f32 v41, v74, v75
    v_cvt_pk_bf16_f32 v42, v76, v77
    v_cvt_pk_bf16_f32 v43, v78, v79
    buffer_store_dwordx4 v[40:43], v16, s[48:51], s8 offen offset:1024 sc0 sc1
    v_mul_f32 v24, 0xbfb8aa3b, v63
    v_mul_f32 v25, v63, v63
    v_mul_f32 v28, v24, v96
    v_mul_f32 v29, v24, v97
    v_mul_f32 v30, v24, v98
    v_mul_f32 v31, v24, v99
    v_mul_f32 v32, v24, v100
    v_mul_f32 v33, v24, v101
    v_mul_f32 v34, v24, v102
    v_mul_f32 v35, v24, v103
    v_exp_f32 v28, v28
    v_exp_f32 v29, v29
    v_exp_f32 v30, v30
    v_exp_f32 v31, v31
    v_exp_f32 v32, v32
    v_exp_f32 v33, v33
    v_exp_f32 v34, v34
    v_exp_f32 v35, v35
    v_mul_f32 v96, v96, v112
    v_mul_f32 v97, v97, v113
    v_mul_f32 v98, v98, v114
    v_mul_f32 v99, v99, v115
    v_mul_f32 v100, v100, v116
    v_mul_f32 v101, v101, v117
    v_mul_f32 v102, v102, v118
    v_mul_f32 v103, v103, v119
    v_add_f32 v28, 1.0, v28
    v_add_f32 v29, 1.0, v29
    v_add_f32 v30, 1.0, v30
    v_add_f32 v31, 1.0, v31
    v_add_f32 v32, 1.0, v32
    v_add_f32 v33, 1.0, v33
    v_add_f32 v34, 1.0, v34
    v_add_f32 v35, 1.0, v35
    v_rcp_f32 v28, v28
    v_rcp_f32 v29, v29
    v_rcp_f32 v30, v30
    v_rcp_f32 v31, v31
    v_rcp_f32 v32, v32
    v_rcp_f32 v33, v33
    v_rcp_f32 v34, v34
    v_rcp_f32 v35, v35
    v_mul_f32 v96, v25, v96
    v_mul_f32 v97, v25, v97
    v_mul_f32 v98, v25, v98
    v_mul_f32 v99, v25, v99
    v_mul_f32 v100, v25, v100
    v_mul_f32 v101, v25, v101
    v_mul_f32 v102, v25, v102
    v_mul_f32 v103, v25, v103
    v_mul_f32 v96, v96, v28
    v_mul_f32 v97, v97, v29
    v_mul_f32 v98, v98, v30
    v_mul_f32 v99, v99, v31
    v_mul_f32 v100, v100, v32
    v_mul_f32 v101, v101, v33
    v_mul_f32 v102, v102, v34
    v_mul_f32 v103, v103, v35
    v_cvt_pk_bf16_f32 v44, v96, v97
    v_cvt_pk_bf16_f32 v45, v98, v99
    v_cvt_pk_bf16_f32 v46, v100, v101
    v_cvt_pk_bf16_f32 v47, v102, v103
    buffer_store_dwordx4 v[44:47], v16, s[48:51], s9 offen offset:0 sc0 sc1
    v_mul_f32 v28, v24, v104
    v_mul_f32 v29, v24, v105
    v_mul_f32 v30, v24, v106
    v_mul_f32 v31, v24, v107
    v_mul_f32 v32, v24, v108
    v_mul_f32 v33, v24, v109
    v_mul_f32 v34, v24, v110
    v_mul_f32 v35, v24, v111
    v_exp_f32 v28, v28
    v_exp_f32 v29, v29
    v_exp_f32 v30, v30
    v_exp_f32 v31, v31
    v_exp_f32 v32, v32
    v_exp_f32 v33, v33
    v_exp_f32 v34, v34
    v_exp_f32 v35, v35
    v_mul_f32 v104, v104, v120
    v_mul_f32 v105, v105, v121
    v_mul_f32 v106, v106, v122
    v_mul_f32 v107, v107, v123
    v_mul_f32 v108, v108, v124
    v_mul_f32 v109, v109, v125
    v_mul_f32 v110, v110, v126
    v_mul_f32 v111, v111, v127
    v_add_f32 v28, 1.0, v28
    v_add_f32 v29, 1.0, v29
    v_add_f32 v30, 1.0, v30
    v_add_f32 v31, 1.0, v31
    v_add_f32 v32, 1.0, v32
    v_add_f32 v33, 1.0, v33
    v_add_f32 v34, 1.0, v34
    v_add_f32 v35, 1.0, v35
    v_rcp_f32 v28, v28
    v_rcp_f32 v29, v29
    v_rcp_f32 v30, v30
    v_rcp_f32 v31, v31
    v_rcp_f32 v32, v32
    v_rcp_f32 v33, v33
    v_rcp_f32 v34, v34
    v_rcp_f32 v35, v35
    v_mul_f32 v104, v25, v104
    v_mul_f32 v105, v25, v105
    v_mul_f32 v106, v25, v106
    v_mul_f32 v107, v25, v107
    v_mul_f32 v108, v25, v108
    v_mul_f32 v109, v25, v109
    v_mul_f32 v110, v25, v110
    v_mul_f32 v111, v25, v111
    v_mul_f32 v104, v104, v28
    v_mul_f32 v105, v105, v29
    v_mul_f32 v106, v106, v30
    v_mul_f32 v107, v107, v31
    v_mul_f32 v108, v108, v32
    v_mul_f32 v109, v109, v33
    v_mul_f32 v110, v110, v34
    v_mul_f32 v111, v111, v35
    v_cvt_pk_bf16_f32 v48, v104, v105
    v_cvt_pk_bf16_f32 v49, v106, v107
    v_cvt_pk_bf16_f32 v50, v108, v109
    v_cvt_pk_bf16_f32 v51, v110, v111
    buffer_store_dwordx4 v[48:51], v16, s[48:51], s9 offen offset:1024 sc0 sc1
    s_branch K1_END
K1_QEPI:
    s_sub_u32 s63, s56, 24
    s_lshl_b32 s63, s63, 2
    s_add_u32 s63, s63, s54
    s_lshl_b32 s63, s63, 11
    s_mul_i32 s8, s4, 40960
    s_add_u32 s8, s8, s63
    s_add_u32 s10, s8, 4096
    s_mul_i32 s9, s5, 40960
    s_add_u32 s9, s9, s63
    s_add_u32 s11, s9, 4096
    v_mul_f32 v24, 0x3ea52b5c, v61
    v_mul_f32 v64, v24, v64
    v_mul_f32 v65, v24, v65
    v_mul_f32 v66, v24, v66
    v_mul_f32 v67, v24, v67
    v_mul_f32 v68, v24, v68
    v_mul_f32 v69, v24, v69
    v_mul_f32 v70, v24, v70
    v_mul_f32 v71, v24, v71
    v_cvt_pk_bf16_f32 v28, v64, v65
    v_cvt_pk_bf16_f32 v29, v66, v67
    v_cvt_pk_bf16_f32 v30, v68, v69
    v_cvt_pk_bf16_f32 v31, v70, v71
    buffer_store_dwordx4 v[28:31], v16, s[48:51], s8 offen offset:0 sc0 sc1
    v_mul_f32 v72, v24, v72
    v_mul_f32 v73, v24, v73
    v_mul_f32 v74, v24, v74
    v_mul_f32 v75, v24, v75
    v_mul_f32 v76, v24, v76
    v_mul_f32 v77, v24, v77
    v_mul_f32 v78, v24, v78
    v_mul_f32 v79, v24, v79
    v_cvt_pk_bf16_f32 v32, v72, v73
    v_cvt_pk_bf16_f32 v33, v74, v75
    v_cvt_pk_bf16_f32 v34, v76, v77
    v_cvt_pk_bf16_f32 v35, v78, v79
    buffer_store_dwordx4 v[32:35], v16, s[48:51], s8 offen offset:1024 sc0 sc1
    v_mul_f32 v80, v24, v80
    v_mul_f32 v81, v24, v81
    v_mul_f32 v82, v24, v82
    v_mul_f32 v83, v24, v83
    v_mul_f32 v84, v24, v84
    v_mul_f32 v85, v24, v85
    v_mul_f32 v86, v24, v86
    v_mul_f32 v87, v24, v87
    v_cvt_pk_bf16_f32 v36, v80, v81
    v_cvt_pk_bf16_f32 v37, v82, v83
    v_cvt_pk_bf16_f32 v38, v84, v85
    v_cvt_pk_bf16_f32 v39, v86, v87
    buffer_store_dwordx4 v[36:39], v16, s[48:51], s10 offen offset:0 sc0 sc1
    v_mul_f32 v88, v24, v88
    v_mul_f32 v89, v24, v89
    v_mul_f32 v90, v24, v90
    v_mul_f32 v91, v24, v91
    v_mul_f32 v92, v24, v92
    v_mul_f32 v93, v24, v93
    v_mul_f32 v94, v24, v94
    v_mul_f32 v95, v24, v95
    v_cvt_pk_bf16_f32 v40, v88, v89
    v_cvt_pk_bf16_f32 v41, v90, v91
    v_cvt_pk_bf16_f32 v42, v92, v93
    v_cvt_pk_bf16_f32 v43, v94, v95
    buffer_store_dwordx4 v[40:43], v16, s[48:51], s10 offen offset:1024 sc0 sc1
    v_mul_f32 v24, 0x3ea52b5c, v63
    v_mul_f32 v96, v24, v96
    v_mul_f32 v97, v24, v97
    v_mul_f32 v98, v24, v98
    v_mul_f32 v99, v24, v99
    v_mul_f32 v100, v24, v100
    v_mul_f32 v101, v24, v101
    v_mul_f32 v102, v24, v102
    v_mul_f32 v103, v24, v103
    v_cvt_pk_bf16_f32 v44, v96, v97
    v_cvt_pk_bf16_f32 v45, v98, v99
    v_cvt_pk_bf16_f32 v46, v100, v101
    v_cvt_pk_bf16_f32 v47, v102, v103
    buffer_store_dwordx4 v[44:47], v16, s[48:51], s9 offen offset:0 sc0 sc1
    v_mul_f32 v104, v24, v104
    v_mul_f32 v105, v24, v105
    v_mul_f32 v106, v24, v106
    v_mul_f32 v107, v24, v107
    v_mul_f32 v108, v24, v108
    v_mul_f32 v109, v24, v109
    v_mul_f32 v110, v24, v110
    v_mul_f32 v111, v24, v111
    v_cvt_pk_bf16_f32 v48, v104, v105
    v_cvt_pk_bf16_f32 v49, v106, v107
    v_cvt_pk_bf16_f32 v50, v108, v109
    v_cvt_pk_bf16_f32 v51, v110, v111
    buffer_store_dwordx4 v[48:51], v16, s[48:51], s9 offen offset:1024 sc0 sc1
    v_mul_f32 v112, v24, v112
    v_mul_f32 v113, v24, v113
    v_mul_f32 v114, v24, v114
    v_mul_f32 v115, v24, v115
    v_mul_f32 v116, v24, v116
    v_mul_f32 v117, v24, v117
    v_mul_f32 v118, v24, v118
    v_mul_f32 v119, v24, v119
    v_cvt_pk_bf16_f32 v52, v112, v113
    v_cvt_pk_bf16_f32 v53, v114, v115
    v_cvt_pk_bf16_f32 v54, v116, v117
    v_cvt_pk_bf16_f32 v55, v118, v119
    buffer_store_dwordx4 v[52:55], v16, s[48:51], s11 offen offset:0 sc0 sc1
    v_mul_f32 v120, v24, v120
    v_mul_f32 v121, v24, v121
    v_mul_f32 v122, v24, v122
    v_mul_f32 v123, v24, v123
    v_mul_f32 v124, v24, v124
    v_mul_f32 v125, v24, v125
    v_mul_f32 v126, v24, v126
    v_mul_f32 v127, v24, v127
    v_cvt_pk_bf16_f32 v56, v120, v121
    v_cvt_pk_bf16_f32 v57, v122, v123
    v_cvt_pk_bf16_f32 v58, v124, v125
    v_cvt_pk_bf16_f32 v59, v126, v127
    buffer_store_dwordx4 v[56:59], v16, s[48:51], s11 offen offset:1024 sc0 sc1
    s_branch K1_END
K1_LOADER:
    s_sub_u32 s53, s52, 8
    s_and_b32 s54, s53, 1
    s_lshr_b32 s4, s53, 1
    v_lshrrev_b32 v1, 3, v0
    v_mul_u32_u24 v1, 1280, v1
    v_and_b32 v2, 7, v0
    v_lshrrev_b32 v3, 4, v0
    v_xor_b32 v2, v2, v3
    v_xor_b32 v4, 4, v2
    v_lshl_add_u32 v5, v2, 4, v1
    v_lshl_add_u32 v6, v4, 4, v1
    v_mov_b32 v1, v5
    v_add_u32 v2, 9216, v6
    v_add_u32 v3, 18432, v5
    v_add_u32 v4, 27648, v6
    s_lshl_b32 s57, s55, 8
    s_lshl_b32 s63, s53, 6
    s_add_u32 s57, s57, s63
    s_mul_i32 s57, s57, 1280
    v_lshrrev_b32 v5, 3, v0
    v_mul_lo_u32 v5, v5, s69
    v_lshrrev_b32 v10, 4, v0
    v_and_b32 v10, 1, v10
    v_lshlrev_b32 v10, 2, v10
    v_and_b32 v11, 7, v0
    v_xor_b32 v10, v10, v11
    v_lshl_add_u32 v5, v10, 4, v5
    s_lshl_b32 s63, s69, 3
    s_sub_u32 s63, s63, 1024
    v_add_u32 v6, s63, v5
    v_add_u32 v7, s63, v6
    v_add_u32 v8, s63, v7
    s_cmp_eq_u32 s54, 0
    s_cselect_b32 s8, s40, s44
    s_cselect_b32 s9, s41, s45
    s_cselect_b32 s10, s42, s46
    s_mov_b32 s11, 0x00020000
    s_lshl_b32 s63, s69, 5
    s_mul_i32 s63, s63, s4
    s_add_u32 s58, s70, s63
    s_lshl_b32 s64, s53, 13
    s_lshl_b32 s66, s54, 13
    s_lshl_b32 s63, s4, 12
    s_add_u32 s66, s66, s63
    s_add_u32 s66, s66, 32768
    v_and_b32 v9, 7, v0
    s_lshl_b32 s63, s68, 4
    s_lshl_b32 s67, s4, 3
    s_add_u32 s63, s63, s67
    v_add_u32 v9, s63, v9
    v_mul_lo_u32 v9, v9, s69
    v_cmp_gt_u32 vcc, 8, v0
    s_lshl_b32 s5, s59, 1
    s_add_u32 s5, s5, s70
    s_mov_b32 s6, s59
    v_mov_b32 v11, 0x7fffff00
    v_cndmask_b32 v9, v11, v9, vcc
    v_mov_b32 v24, 0
    v_mov_b32 v25, 0
    v_mov_b32 v26, 0
    v_mov_b32 v27, 0
    v_mov_b32 v28, 0
    v_mov_b32 v29, 0
    v_mov_b32 v30, 0
    v_mov_b32 v31, 0
    v_lshrrev_b32 v15, 2, v10
    v_lshlrev_b32 v15, 12, v15
    v_and_b32 v14, 3, v10
    v_lshl_add_u32 v15, v14, 9, v15
    v_lshrrev_b32 v14, 3, v0
    v_lshl_add_u32 v15, v14, 2, v15
    s_lshl_b32 s63, s54, 11
    s_lshl_b32 s67, s4, 5
    s_add_u32 s63, s63, s67
    s_add_u32 s63, s63, 147456
    v_add_u32 v15, s63, v15
    s_mov_b32 s60, 0
    s_mov_b32 s61, 0
    s_add_u32 m0, s60, s66
    s_nop 0
    buffer_load_dwordx4 v5, s[8:11], s58 offen offset:0  lds
    buffer_load_dwordx4 v6, s[8:11], s58 offen offset:1024  lds
    buffer_load_dwordx4 v7, s[8:11], s58 offen offset:2048  lds
    buffer_load_dwordx4 v8, s[8:11], s58 offen offset:3072  lds
    s_add_u32 s63, s64, 0
    s_add_u32 m0, s60, s63
    s_add_u32 s67, s57, 0
    buffer_load_dwordx4 v1, s[36:39], s67 offen offset:0  lds
    buffer_load_dwordx4 v2, s[36:39], s67 offen offset:1024  lds
    buffer_load_dwordx4 v3, s[36:39], s67 offen offset:2048  lds
    buffer_load_dwordx4 v4, s[36:39], s67 offen offset:3072  lds
    s_add_u32 s63, s64, 4096
    s_add_u32 m0, s60, s63
    s_add_u32 s67, s57, 40960
    buffer_load_dwordx4 v1, s[36:39], s67 offen offset:0  lds
    buffer_load_dwordx4 v2, s[36:39], s67 offen offset:1024  lds
    buffer_load_dwordx4 v3, s[36:39], s67 offen offset:2048  lds
    buffer_load_dwordx4 v4, s[36:39], s67 offen offset:3072  lds
    s_add_u32 s57, s57, 128
    s_add_u32 s58, s58, s59
    s_add_u32 s60, s60, 49152
    s_cmp_eq_u32 s60, 147456
    s_cselect_b32 s60, 0, s60
    s_add_u32 m0, s60, s66
    s_nop 0
    buffer_load_dwordx4 v5, s[8:11], s58 offen offset:0  lds
    buffer_load_dwordx4 v6, s[8:11], s58 offen offset:1024  lds
    buffer_load_dwordx4 v7, s[8:11], s58 offen offset:2048  lds
    buffer_load_dwordx4 v8, s[8:11], s58 offen offset:3072  lds
    s_add_u32 s63, s64, 0
    s_add_u32 m0, s60, s63
    s_add_u32 s67, s57, 0
    buffer_load_dwordx4 v1, s[36:39], s67 offen offset:0  lds
    buffer_load_dwordx4 v2, s[36:39], s67 offen offset:1024  lds
    buffer_load_dwordx4 v3, s[36:39], s67 offen offset:2048  lds
    buffer_load_dwordx4 v4, s[36:39], s67 offen offset:3072  lds
    s_add_u32 s63, s64, 4096
    s_add_u32 m0, s60, s63
    s_add_u32 s67, s57, 40960
    buffer_load_dwordx4 v1, s[36:39], s67 offen offset:0  lds
    buffer_load_dwordx4 v2, s[36:39], s67 offen offset:1024  lds
    buffer_load_dwordx4 v3, s[36:39], s67 offen offset:2048  lds
    buffer_load_dwordx4 v4, s[36:39], s67 offen offset:3072  lds
    s_add_u32 s57, s57, 128
    s_add_u32 s58, s58, s59
    s_add_u32 s60, s60, 49152
    s_cmp_eq_u32 s60, 147456
    s_cselect_b32 s60, 0, s60
    s_waitcnt vmcnt(12)
    s_barrier
    s_add_u32 m0, s60, s66
    s_nop 0
    buffer_load_dwordx4 v5, s[8:11], s58 offen offset:0  lds
    buffer_load_dwordx4 v6, s[8:11], s58 offen offset:1024  lds
    buffer_load_dwordx4 v7, s[8:11], s58 offen offset:2048  lds
    buffer_load_dwordx4 v8, s[8:11], s58 offen offset:3072  lds
    s_add_u32 s63, s64, 0
    s_add_u32 m0, s60, s63
    s_add_u32 s67, s57, 0
    buffer_load_dwordx4 v1, s[36:39], s67 offen offset:0  lds
    buffer_load_dwordx4 v2, s[36:39], s67 offen offset:1024  lds
    buffer_load_dwordx4 v3, s[36:39], s67 offen offset:2048  lds
    buffer_load_dwordx4 v4, s[36:39], s67 offen offset:3072  lds
    s_add_u32 s63, s64, 4096
    s_add_u32 m0, s60, s63
    s_add_u32 s67, s57, 40960
    buffer_load_dwordx4 v1, s[36:39], s67 offen offset:0  lds
    buffer_load_dwordx4 v2, s[36:39], s67 offen offset:1024  lds
    buffer_load_dwordx4 v3, s[36:39], s67 offen offset:2048  lds
    buffer_load_dwordx4 v4, s[36:39], s67 offen offset:3072  lds
    s_add_u32 s57, s57, 128
    s_add_u32 s58, s58, s59
    s_add_u32 s60, s60, 49152
    s_cmp_eq_u32 s60, 147456
    s_cselect_b32 s60, 0, s60
    s_mov_b32 s62, 7
K1_LLOOP:
    s_waitcnt vmcnt(12)
    s_barrier
    s_add_u32 m0, s60, s66
    s_nop 0
    buffer_load_dwordx4 v5, s[8:11], s58 offen offset:0  lds
    buffer_load_dwordx4 v6, s[8:11], s58 offen offset:1024  lds
    buffer_load_dwordx4 v7, s[8:11], s58 offen offset:2048  lds
    buffer_load_dwordx4 v8, s[8:11], s58 offen offset:3072  lds
    s_add_u32 s63, s64, 0
    s_add_u32 m0, s60, s63
    s_add_u32 s67, s57, 0
    buffer_load_dwordx4 v1, s[36:39], s67 offen offset:0  lds
    buffer_load_dwordx4 v2, s[36:39], s67 offen offset:1024  lds
    buffer_load_dwordx4 v3, s[36:39], s67 offen offset:2048  lds
    buffer_load_dwordx4 v4, s[36:39], s67 offen offset:3072  lds
    s_add_u32 s63, s64, 4096
    s_add_u32 m0, s60, s63
    s_add_u32 s67, s57, 40960
    buffer_load_dwordx4 v1, s[36:39], s67 offen offset:0  lds
    buffer_load_dwordx4 v2, s[36:39], s67 offen offset:1024  lds
    buffer_load_dwordx4 v3, s[36:39], s67 offen offset:2048  lds
    buffer_load_dwordx4 v4, s[36:39], s67 offen offset:3072  lds
    s_add_u32 s57, s57, 128
    s_add_u32 s58, s58, s59
    s_add_u32 s60, s60, 49152
    s_cmp_eq_u32 s60, 147456
    s_cselect_b32 s60, 0, s60
    s_sub_u32 s62, s62, 1
    s_cmp_lg_u32 s62, 0
    s_cbranch_scc1 K1_LLOOP
    v_and_b32 v3, 7, v0
    v_lshlrev_b32 v3, 2, v3
    s_mov_b32 s27, 19879936
    v_mov_b32 v5, 0
    buffer_load_dword v6, v5, s[72:75], 0 offen sc1
    buffer_load_dword v4, v3, s[48:51], s27 offen sc1
    s_waitcnt vmcnt(14)
    s_barrier
    s_waitcnt vmcnt(0)
    v_readfirstlane_b32 s3, v6
    s_barrier
    s_cmp_lg_u32 s3, 0
    s_cbranch_scc1 PB_G2
    s_branch PB_G
K1_KV:
    s_mov_b32 s40, s20
    s_mov_b32 s41, s21
    s_mov_b32 s42, 25600
    s_mov_b32 s43, 0x00020000
    s_mov_b32 s44, s22
    s_mov_b32 s45, s23
    s_mov_b32 s46, 25600
    s_mov_b32 s47, 0x00020000
    s_lshl_b32 s63, s52, 10
    s_add_u32 s67, s63, 0
    s_add_u32 m0, s67, 98304
    s_nop 0
    buffer_load_dwordx4 v16, s[40:43], s67 offen  lds
    s_add_u32 m0, s67, 126976
    s_nop 0
    buffer_load_dwordx4 v16, s[44:47], s67 offen  lds
    s_add_u32 s67, s63, 8192
    s_add_u32 m0, s67, 98304
    s_nop 0
    buffer_load_dwordx4 v16, s[40:43], s67 offen  lds
    s_add_u32 m0, s67, 126976
    s_nop 0
    buffer_load_dwordx4 v16, s[44:47], s67 offen  lds
    s_add_u32 s67, s63, 16384
    s_add_u32 m0, s67, 98304
    s_nop 0
    buffer_load_dwordx4 v16, s[40:43], s67 offen  lds
    s_add_u32 m0, s67, 126976
    s_nop 0
    buffer_load_dwordx4 v16, s[44:47], s67 offen  lds
    s_cmp_ge_u32 s52, 4
    s_cbranch_scc1 K1_KV_W3
    s_add_u32 s67, s63, 24576
    s_add_u32 m0, s67, 98304
    s_nop 0
    buffer_load_dwordx4 v16, s[40:43], s67 offen  lds
    s_add_u32 m0, s67, 126976
    s_nop 0
    buffer_load_dwordx4 v16, s[44:47], s67 offen  lds
K1_KV_W3:
    s_mov_b32 s60, 0
    s_add_u32 m0, s60, s64
    s_nop 0
    buffer_load_dwordx4 v1, s[36:39], s57 offen offset:0  lds
    buffer_load_dwordx4 v2, s[36:39], s57 offen offset:1024  lds
    buffer_load_dwordx4 v3, s[36:39], s57 offen offset:2048  lds
    buffer_load_dwordx4 v4, s[36:39], s57 offen offset:3072  lds
    s_add_u32 s57, s57, 128
    s_add_u32 s60, s60, 32768
    s_cmp_eq_u32 s60, 98304
    s_cselect_b32 s60, 0, s60
    s_add_u32 m0, s60, s64
    s_nop 0
    buffer_load_dwordx4 v1, s[36:39], s57 offen offset:0  lds
    buffer_load_dwordx4 v2, s[36:39], s57 offen offset:1024  lds
    buffer_load_dwordx4 v3, s[36:39], s57 offen offset:2048  lds
    buffer_load_dwordx4 v4, s[36:39], s57 offen offset:3072  lds
    s_add_u32 s57, s57, 128
    s_add_u32 s60, s60, 32768
    s_cmp_eq_u32 s60, 98304
    s_cselect_b32 s60, 0, s60
    s_add_u32 m0, s60, s64
    s_nop 0
    buffer_load_dwordx4 v1, s[36:39], s57 offen offset:0  lds
    buffer_load_dwordx4 v2, s[36:39], s57 offen offset:1024  lds
    buffer_load_dwordx4 v3, s[36:39], s57 offen offset:2048  lds
    buffer_load_dwordx4 v4, s[36:39], s57 offen offset:3072  lds
    s_add_u32 s57, s57, 128
    s_add_u32 s60, s60, 32768
    s_cmp_eq_u32 s60, 98304
    s_cselect_b32 s60, 0, s60
    s_lshl_b32 s63, s55, 8
    s_lshl_b32 s67, s56, 3
    s_add_u32 s63, s63, s67
    s_add_u32 s63, s63, s52
    v_mov_b32 v23, s63
    s_mul_i32 s63, s63, 1280
    v_lshlrev_b32 v128, 5, v0
    v_mov_b32 v129, 0x7f000000
    v_cmp_gt_u32 vcc, 40, v0
    s_nop 1
    v_cndmask_b32 v128, v129, v128, vcc
    buffer_load_dwordx4 v[136:139], v128, s[36:39], s63 offen offset:0
    buffer_load_dwordx4 v[140:143], v128, s[36:39], s63 offen offset:16
    s_waitcnt vmcnt(0)
    v_dot2_f32_bf16 v17, v136, s66, v17
    v_dot2_f32_bf16 v19, v136, v136, v19
    v_dot2_f32_bf16 v18, v137, s66, v18
    v_dot2_f32_bf16 v20, v137, v137, v20
    v_dot2_f32_bf16 v17, v138, s66, v17
    v_dot2_f32_bf16 v19, v138, v138, v19
    v_dot2_f32_bf16 v18, v139, s66, v18
    v_dot2_f32_bf16 v20, v139, v139, v20
    v_dot2_f32_bf16 v17, v140, s66, v17
    v_dot2_f32_bf16 v19, v140, v140, v19
    v_dot2_f32_bf16 v18, v141, s66, v18
    v_dot2_f32_bf16 v20, v141, v141, v20
    v_dot2_f32_bf16 v17, v142, s66, v17
    v_dot2_f32_bf16 v19, v142, v142, v19
    v_dot2_f32_bf16 v18, v143, s66, v18
    v_dot2_f32_bf16 v20, v143, v143, v20
    s_nop 1
    v_add_f32 v17, v17, v18
    v_add_f32 v19, v19, v20
    s_nop 0
    v_add_f32_dpp v17, v17, v17 row_ror:8 row_mask:0xf bank_mask:0xf
    v_add_f32_dpp v19, v19, v19 row_ror:8 row_mask:0xf bank_mask:0xf
    s_nop 0
    v_add_f32_dpp v17, v17, v17 row_ror:4 row_mask:0xf bank_mask:0xf
    v_add_f32_dpp v19, v19, v19 row_ror:4 row_mask:0xf bank_mask:0xf
    s_nop 0
    v_add_f32_dpp v17, v17, v17 row_ror:2 row_mask:0xf bank_mask:0xf
    v_add_f32_dpp v19, v19, v19 row_ror:2 row_mask:0xf bank_mask:0xf
    s_nop 0
    v_add_f32_dpp v17, v17, v17 row_ror:1 row_mask:0xf bank_mask:0xf
    v_add_f32_dpp v19, v19, v19 row_ror:1 row_mask:0xf bank_mask:0xf
    s_nop 0
    v_add_f32_dpp v17, v17, v17 row_bcast:15 row_mask:0xa bank_mask:0xf
    v_add_f32_dpp v19, v19, v19 row_bcast:15 row_mask:0xa bank_mask:0xf
    s_nop 0
    v_add_f32_dpp v17, v17, v17 row_bcast:31 row_mask:0xc bank_mask:0xf
    v_add_f32_dpp v19, v19, v19 row_bcast:31 row_mask:0xc bank_mask:0xf
    v_mul_f32 v17, 0x3acccccd, v17
    v_mul_f32 v19, 0x3acccccd, v19
    v_fma_f32 v19, -v17, v17, v19
    v_max_f32 v19, 0, v19
    v_cvt_pk_bf16_f32 v128, v17, v17
    v_xor_b32 v128, 0x80008000, v128
    v_cvt_pk_bf16_f32 v19, v19, v19
    v_lshlrev_b32 v19, 16, v19
    v_add_f32 v19, 0x3727c5ac, v19
    v_cvt_pk_bf16_f32 v19, v19, v19
    v_lshlrev_b32 v19, 16, v19
    v_sqrt_f32 v19, v19
    s_nop 0
    v_cvt_pk_bf16_f32 v19, v19, v19
    v_lshlrev_b32 v19, 16, v19
    v_rcp_f32 v129, v19
    v_lshlrev_b32 v23, 3, v23
    v_cmp_eq_u32 vcc, 63, v0
    s_nop 0
    s_and_saveexec_b64 s[78:79], vcc
    buffer_store_dwordx2 v[128:129], v23, s[48:51], s76 offen sc0 sc1
    s_mov_b64 exec, s[78:79]
    s_waitcnt vmcnt(0)
    s_barrier
    s_cmp_eq_u32 s52, 0
    s_cbranch_scc0 K1_KVSG
    v_mov_b32 v135, 0
K1_NC3:
    buffer_load_dword v134, v135, s[72:75], 0 offen sc1
    s_waitcnt vmcnt(0)
    v_readfirstlane_b32 s3, v134
    s_nop 3
    s_cmp_lg_u32 s3, 0
    s_cbranch_scc1 K1_NC3_OK
    s_sleep 2
    s_branch K1_NC3
K1_NC3_OK:
    s_mov_b64 exec, 1
    v_mov_b32 v134, s3
    s_lshl_b32 s63, s2, 2
    s_add_u32 s63, s63, 19880960
    s_nop 1
    buffer_store_dword v134, v135, s[48:51], s63 offen sc0 sc1
    v_mov_b32 v135, 163328
    s_nop 0
    ds_write_b32 v135, v134 offset:4
    s_mov_b64 exec, -1
K1_KVSG:
    v_mov_b32 v17, 0
    v_mov_b32 v18, 0
    v_mov_b32 v19, 0
    v_mov_b32 v20, 0
    s_lshl_b32 s63, s52, 5
    v_and_b32 v10, 31, v0
    v_lshrrev_b32 v11, 1, v10
    v_and_b32 v11, 7, v11
    v_lshrrev_b32 v12, 5, v0
    v_add_u32 v10, s63, v10
    v_lshlrev_b32 v10, 7, v10
    v_add_u32 v13, 0, v12
    v_xor_b32 v13, v13, v11
    v_lshl_add_u32 v6, v13, 4, v10
    v_add_u32 v13, 2, v12
    v_xor_b32 v13, v13, v11
    v_lshl_add_u32 v7, v13, 4, v10
    v_add_u32 v13, 4, v12
    v_xor_b32 v13, v13, v11
    v_lshl_add_u32 v8, v13, 4, v10
    v_add_u32 v13, 6, v12
    v_xor_b32 v13, v13, v11
    v_lshl_add_u32 v9, v13, 4, v10
    v_lshrrev_b32 v11, 5, v0
    v_and_b32 v12, 15, v0
    v_lshrrev_b32 v13, 2, v12
    v_and_b32 v12, 3, v12
    v_lshl_add_u32 v14, v11, 3, v13
    v_mul_u32_u24 v14, 40, v14
    v_lshrrev_b32 v15, 4, v0
    v_and_b32 v15, 1, v15
    v_lshl_add_u32 v14, v15, 5, v14
    v_lshl_add_u32 v14, v12, 3, v14
    v_add_u32 v15, 98304, v14
    v_mov_b32 v64, 0
    v_mov_b32 v65, 0
    v_mov_b32 v66, 0
    v_mov_b32 v67, 0
    v_mov_b32 v68, 0
    v_mov_b32 v69, 0
    v_mov_b32 v70, 0
    v_mov_b32 v71, 0
    v_mov_b32 v72, 0
    v_mov_b32 v73, 0
    v_mov_b32 v74, 0
    v_mov_b32 v75, 0
    v_mov_b32 v76, 0
    v_mov_b32 v77, 0
    v_mov_b32 v78, 0
    v_mov_b32 v79, 0
    v_mov_b32 v80, 0
    v_mov_b32 v81, 0
    v_mov_b32 v82, 0
    v_mov_b32 v83, 0
    v_mov_b32 v84, 0
    v_mov_b32 v85, 0
    v_mov_b32 v86, 0
    v_mov_b32 v87, 0
    v_mov_b32 v88, 0
    v_mov_b32 v89, 0
    v_mov_b32 v90, 0
    v_mov_b32 v91, 0
    v_mov_b32 v92, 0
    v_mov_b32 v93, 0
    v_mov_b32 v94, 0
    v_mov_b32 v95, 0
    s_mov_b32 s61, 0
    v_add_u32 v11, s61, v6
    v_add_u32 v12, s61, v7
    v_add_u32 v13, s61, v8
    v_add_u32 v14, s61, v9
    s_add_u32 s61, s61, 32768
    s_cmp_eq_u32 s61, 98304
    s_cselect_b32 s61, 0, s61
    ds_read_b128 v[24:27], v11
    ds_read_b64_tr_b16 v[40:41], v15 offset:0
    ds_read_b64_tr_b16 v[42:43], v15 offset:160
    ds_read_b64_tr_b16 v[44:45], v15 offset:28672
    ds_read_b64_tr_b16 v[46:47], v15 offset:28832
    s_xor_b32 s6, s53, 0xff
    s_cmp_eq_u32 s54, 0
    s_cselect_b32 s5, s53, 0xff
    s_mov_b32 s62, 7
K1_KVLOOP:
    s_waitcnt lgkmcnt(0)
    v_mfma_f32_32x32x16_bf16 v[64:79], v[40:43], v[24:27], v[64:79]
    ds_read_b128 v[32:35], v12
    ds_read_b64_tr_b16 v[48:49], v15 offset:640
    ds_read_b64_tr_b16 v[50:51], v15 offset:800
    v_mfma_f32_32x32x16_bf16 v[80:95], v[24:27], v[44:47], v[80:95]
    ds_read_b64_tr_b16 v[52:53], v15 offset:29312
    ds_read_b64_tr_b16 v[54:55], v15 offset:29472
    s_cmp_eq_u32 s5, 0
    s_cbranch_scc0 K1_KCS7
    v_lshlrev_b32 v132, 16, v40
    v_and_b32 v133, 0xffff0000, v40
    v_add_f32 v21, v21, v132
    v_add_f32 v21, v21, v133
    v_lshlrev_b32 v134, 16, v44
    v_and_b32 v135, 0xffff0000, v44
    v_add_f32 v22, v22, v134
    v_add_f32 v22, v22, v135
    v_lshlrev_b32 v132, 16, v41
    v_and_b32 v133, 0xffff0000, v41
    v_add_f32 v21, v21, v132
    v_add_f32 v21, v21, v133
    v_lshlrev_b32 v134, 16, v45
    v_and_b32 v135, 0xffff0000, v45
    v_add_f32 v22, v22, v134
    v_add_f32 v22, v22, v135
    v_lshlrev_b32 v132, 16, v42
    v_and_b32 v133, 0xffff0000, v42
    v_add_f32 v21, v21, v132
    v_add_f32 v21, v21, v133
    v_lshlrev_b32 v134, 16, v46
    v_and_b32 v135, 0xffff0000, v46
    v_add_f32 v22, v22, v134
    v_add_f32 v22, v22, v135
    v_lshlrev_b32 v132, 16, v43
    v_and_b32 v133, 0xffff0000, v43
    v_add_f32 v21, v21, v132
    v_add_f32 v21, v21, v133
    v_lshlrev_b32 v134, 16, v47
    v_and_b32 v135, 0xffff0000, v47
    v_add_f32 v22, v22, v134
    v_add_f32 v22, v22, v135
K1_KCS7:
    s_waitcnt lgkmcnt(0)
    v_mfma_f32_32x32x16_bf16 v[64:79], v[48:51], v[32:35], v[64:79]
    ds_read_b128 v[24:27], v13
    ds_read_b64_tr_b16 v[40:41], v15 offset:1280
    ds_read_b64_tr_b16 v[42:43], v15 offset:1440
    v_mfma_f32_32x32x16_bf16 v[80:95], v[32:35], v[52:55], v[80:95]
    ds_read_b64_tr_b16 v[44:45], v15 offset:29952
    ds_read_b64_tr_b16 v[46:47], v15 offset:30112
    s_cmp_eq_u32 s5, 1
    s_cbranch_scc0 K1_KCS8
    v_lshlrev_b32 v132, 16, v48
    v_and_b32 v133, 0xffff0000, v48
    v_add_f32 v21, v21, v132
    v_add_f32 v21, v21, v133
    v_lshlrev_b32 v134, 16, v52
    v_and_b32 v135, 0xffff0000, v52
    v_add_f32 v22, v22, v134
    v_add_f32 v22, v22, v135
    v_lshlrev_b32 v132, 16, v49
    v_and_b32 v133, 0xffff0000, v49
    v_add_f32 v21, v21, v132
    v_add_f32 v21, v21, v133
    v_lshlrev_b32 v134, 16, v53
    v_and_b32 v135, 0xffff0000, v53
    v_add_f32 v22, v22, v134
    v_add_f32 v22, v22, v135
    v_lshlrev_b32 v132, 16, v50
    v_and_b32 v133, 0xffff0000, v50
    v_add_f32 v21, v21, v132
    v_add_f32 v21, v21, v133
    v_lshlrev_b32 v134, 16, v54
    v_and_b32 v135, 0xffff0000, v54
    v_add_f32 v22, v22, v134
    v_add_f32 v22, v22, v135
    v_lshlrev_b32 v132, 16, v51
    v_and_b32 v133, 0xffff0000, v51
    v_add_f32 v21, v21, v132
    v_add_f32 v21, v21, v133
    v_lshlrev_b32 v134, 16, v55
    v_and_b32 v135, 0xffff0000, v55
    v_add_f32 v22, v22, v134
    v_add_f32 v22, v22, v135
K1_KCS8:
    s_waitcnt lgkmcnt(0)
    v_mfma_f32_32x32x16_bf16 v[64:79], v[40:43], v[24:27], v[64:79]
    ds_read_b128 v[32:35], v14
    ds_read_b64_tr_b16 v[48:49], v15 offset:1920
    ds_read_b64_tr_b16 v[50:51], v15 offset:2080
    v_mfma_f32_32x32x16_bf16 v[80:95], v[24:27], v[44:47], v[80:95]
    ds_read_b64_tr_b16 v[52:53], v15 offset:30592
    ds_read_b64_tr_b16 v[54:55], v15 offset:30752
    s_cmp_eq_u32 s5, 2
    s_cbranch_scc0 K1_KCS9
    v_lshlrev_b32 v132, 16, v40
    v_and_b32 v133, 0xffff0000, v40
    v_add_f32 v21, v21, v132
    v_add_f32 v21, v21, v133
    v_lshlrev_b32 v134, 16, v44
    v_and_b32 v135, 0xffff0000, v44
    v_add_f32 v22, v22, v134
    v_add_f32 v22, v22, v135
    v_lshlrev_b32 v132, 16, v41
    v_and_b32 v133, 0xffff0000, v41
    v_add_f32 v21, v21, v132
    v_add_f32 v21, v21, v133
    v_lshlrev_b32 v134, 16, v45
    v_and_b32 v135, 0xffff0000, v45
    v_add_f32 v22, v22, v134
    v_add_f32 v22, v22, v135
    v_lshlrev_b32 v132, 16, v42
    v_and_b32 v133, 0xffff0000, v42
    v_add_f32 v21, v21, v132
    v_add_f32 v21, v21, v133
    v_lshlrev_b32 v134, 16, v46
    v_and_b32 v135, 0xffff0000, v46
    v_add_f32 v22, v22, v134
    v_add_f32 v22, v22, v135
    v_lshlrev_b32 v132, 16, v43
    v_and_b32 v133, 0xffff0000, v43
    v_add_f32 v21, v21, v132
    v_add_f32 v21, v21, v133
    v_lshlrev_b32 v134, 16, v47
    v_and_b32 v135, 0xffff0000, v47
    v_add_f32 v22, v22, v134
    v_add_f32 v22, v22, v135
K1_KCS9:
    s_waitcnt lgkmcnt(0)
    s_waitcnt vmcnt(4)
    s_add_u32 m0, s60, s64
    s_nop 0
    buffer_load_dwordx4 v1, s[36:39], s57 offen offset:0  lds
    buffer_load_dwordx4 v2, s[36:39], s57 offen offset:1024  lds
    buffer_load_dwordx4 v3, s[36:39], s57 offen offset:2048  lds
    buffer_load_dwordx4 v4, s[36:39], s57 offen offset:3072  lds
    s_add_u32 s57, s57, 128
    s_add_u32 s60, s60, 32768
    s_cmp_eq_u32 s60, 98304
    s_cselect_b32 s60, 0, s60
    v_add_u32 v11, s61, v6
    v_add_u32 v12, s61, v7
    v_add_u32 v13, s61, v8
    v_add_u32 v14, s61, v9
    s_add_u32 s61, s61, 32768
    s_cmp_eq_u32 s61, 98304
    s_cselect_b32 s61, 0, s61
    v_add_u32 v15, 2560, v15
    v_mfma_f32_32x32x16_bf16 v[64:79], v[48:51], v[32:35], v[64:79]
    ds_read_b128 v[24:27], v11
    ds_read_b64_tr_b16 v[40:41], v15 offset:0
    ds_read_b64_tr_b16 v[42:43], v15 offset:160
    v_mfma_f32_32x32x16_bf16 v[80:95], v[32:35], v[52:55], v[80:95]
    ds_read_b64_tr_b16 v[44:45], v15 offset:28672
    ds_read_b64_tr_b16 v[46:47], v15 offset:28832
    s_cmp_eq_u32 s5, 3
    s_cbranch_scc0 K1_KCS10
    v_lshlrev_b32 v132, 16, v48
    v_and_b32 v133, 0xffff0000, v48
    v_add_f32 v21, v21, v132
    v_add_f32 v21, v21, v133
    v_lshlrev_b32 v134, 16, v52
    v_and_b32 v135, 0xffff0000, v52
    v_add_f32 v22, v22, v134
    v_add_f32 v22, v22, v135
    v_lshlrev_b32 v132, 16, v49
    v_and_b32 v133, 0xffff0000, v49
    v_add_f32 v21, v21, v132
    v_add_f32 v21, v21, v133
    v_lshlrev_b32 v134, 16, v53
    v_and_b32 v135, 0xffff0000, v53
    v_add_f32 v22, v22, v134
    v_add_f32 v22, v22, v135
    v_lshlrev_b32 v132, 16, v50
    v_and_b32 v133, 0xffff0000, v50
    v_add_f32 v21, v21, v132
    v_add_f32 v21, v21, v133
    v_lshlrev_b32 v134, 16, v54
    v_and_b32 v135, 0xffff0000, v54
    v_add_f32 v22, v22, v134
    v_add_f32 v22, v22, v135
    v_lshlrev_b32 v132, 16, v51
    v_and_b32 v133, 0xffff0000, v51
    v_add_f32 v21, v21, v132
    v_add_f32 v21, v21, v133
    v_lshlrev_b32 v134, 16, v55
    v_and_b32 v135, 0xffff0000, v55
    v_add_f32 v22, v22, v134
    v_add_f32 v22, v22, v135
K1_KCS10:
    s_xor_b32 s5, s5, s6
    s_sub_u32 s62, s62, 1
    s_cmp_lg_u32 s62, 0
    s_cbranch_scc1 K1_KVLOOP
    s_waitcnt lgkmcnt(0)
    v_mfma_f32_32x32x16_bf16 v[64:79], v[40:43], v[24:27], v[64:79]
    ds_read_b128 v[32:35], v12
    ds_read_b64_tr_b16 v[48:49], v15 offset:640
    ds_read_b64_tr_b16 v[50:51], v15 offset:800
    v_mfma_f32_32x32x16_bf16 v[80:95], v[24:27], v[44:47], v[80:95]
    ds_read_b64_tr_b16 v[52:53], v15 offset:29312
    ds_read_b64_tr_b16 v[54:55], v15 offset:29472
    s_cmp_eq_u32 s5, 0
    s_cbranch_scc0 K1_KCS11
    v_lshlrev_b32 v132, 16, v40
    v_and_b32 v133, 0xffff0000, v40
    v_add_f32 v21, v21, v132
    v_add_f32 v21, v21, v133
    v_lshlrev_b32 v134, 16, v44
    v_and_b32 v135, 0xffff0000, v44
    v_add_f32 v22, v22, v134
    v_add_f32 v22, v22, v135
    v_lshlrev_b32 v132, 16, v41
    v_and_b32 v133, 0xffff0000, v41
    v_add_f32 v21, v21, v132
    v_add_f32 v21, v21, v133
    v_lshlrev_b32 v134, 16, v45
    v_and_b32 v135, 0xffff0000, v45
    v_add_f32 v22, v22, v134
    v_add_f32 v22, v22, v135
    v_lshlrev_b32 v132, 16, v42
    v_and_b32 v133, 0xffff0000, v42
    v_add_f32 v21, v21, v132
    v_add_f32 v21, v21, v133
    v_lshlrev_b32 v134, 16, v46
    v_and_b32 v135, 0xffff0000, v46
    v_add_f32 v22, v22, v134
    v_add_f32 v22, v22, v135
    v_lshlrev_b32 v132, 16, v43
    v_and_b32 v133, 0xffff0000, v43
    v_add_f32 v21, v21, v132
    v_add_f32 v21, v21, v133
    v_lshlrev_b32 v134, 16, v47
    v_and_b32 v135, 0xffff0000, v47
    v_add_f32 v22, v22, v134
    v_add_f32 v22, v22, v135
K1_KCS11:
    s_waitcnt lgkmcnt(0)
    v_mfma_f32_32x32x16_bf16 v[64:79], v[48:51], v[32:35], v[64:79]
    ds_read_b128 v[24:27], v13
    ds_read_b64_tr_b16 v[40:41], v15 offset:1280
    ds_read_b64_tr_b16 v[42:43], v15 offset:1440
    v_mfma_f32_32x32x16_bf16 v[80:95], v[32:35], v[52:55], v[80:95]
    ds_read_b64_tr_b16 v[44:45], v15 offset:29952
    ds_read_b64_tr_b16 v[46:47], v15 offset:30112
    s_cmp_eq_u32 s5, 1
    s_cbranch_scc0 K1_KCS12
    v_lshlrev_b32 v132, 16, v48
    v_and_b32 v133, 0xffff0000, v48
    v_add_f32 v21, v21, v132
    v_add_f32 v21, v21, v133
    v_lshlrev_b32 v134, 16, v52
    v_and_b32 v135, 0xffff0000, v52
    v_add_f32 v22, v22, v134
    v_add_f32 v22, v22, v135
    v_lshlrev_b32 v132, 16, v49
    v_and_b32 v133, 0xffff0000, v49
    v_add_f32 v21, v21, v132
    v_add_f32 v21, v21, v133
    v_lshlrev_b32 v134, 16, v53
    v_and_b32 v135, 0xffff0000, v53
    v_add_f32 v22, v22, v134
    v_add_f32 v22, v22, v135
    v_lshlrev_b32 v132, 16, v50
    v_and_b32 v133, 0xffff0000, v50
    v_add_f32 v21, v21, v132
    v_add_f32 v21, v21, v133
    v_lshlrev_b32 v134, 16, v54
    v_and_b32 v135, 0xffff0000, v54
    v_add_f32 v22, v22, v134
    v_add_f32 v22, v22, v135
    v_lshlrev_b32 v132, 16, v51
    v_and_b32 v133, 0xffff0000, v51
    v_add_f32 v21, v21, v132
    v_add_f32 v21, v21, v133
    v_lshlrev_b32 v134, 16, v55
    v_and_b32 v135, 0xffff0000, v55
    v_add_f32 v22, v22, v134
    v_add_f32 v22, v22, v135
K1_KCS12:
    s_waitcnt lgkmcnt(0)
    v_mfma_f32_32x32x16_bf16 v[64:79], v[40:43], v[24:27], v[64:79]
    ds_read_b128 v[32:35], v14
    ds_read_b64_tr_b16 v[48:49], v15 offset:1920
    ds_read_b64_tr_b16 v[50:51], v15 offset:2080
    v_mfma_f32_32x32x16_bf16 v[80:95], v[24:27], v[44:47], v[80:95]
    ds_read_b64_tr_b16 v[52:53], v15 offset:30592
    ds_read_b64_tr_b16 v[54:55], v15 offset:30752
    s_cmp_eq_u32 s5, 2
    s_cbranch_scc0 K1_KCS13
    v_lshlrev_b32 v132, 16, v40
    v_and_b32 v133, 0xffff0000, v40
    v_add_f32 v21, v21, v132
    v_add_f32 v21, v21, v133
    v_lshlrev_b32 v134, 16, v44
    v_and_b32 v135, 0xffff0000, v44
    v_add_f32 v22, v22, v134
    v_add_f32 v22, v22, v135
    v_lshlrev_b32 v132, 16, v41
    v_and_b32 v133, 0xffff0000, v41
    v_add_f32 v21, v21, v132
    v_add_f32 v21, v21, v133
    v_lshlrev_b32 v134, 16, v45
    v_and_b32 v135, 0xffff0000, v45
    v_add_f32 v22, v22, v134
    v_add_f32 v22, v22, v135
    v_lshlrev_b32 v132, 16, v42
    v_and_b32 v133, 0xffff0000, v42
    v_add_f32 v21, v21, v132
    v_add_f32 v21, v21, v133
    v_lshlrev_b32 v134, 16, v46
    v_and_b32 v135, 0xffff0000, v46
    v_add_f32 v22, v22, v134
    v_add_f32 v22, v22, v135
    v_lshlrev_b32 v132, 16, v43
    v_and_b32 v133, 0xffff0000, v43
    v_add_f32 v21, v21, v132
    v_add_f32 v21, v21, v133
    v_lshlrev_b32 v134, 16, v47
    v_and_b32 v135, 0xffff0000, v47
    v_add_f32 v22, v22, v134
    v_add_f32 v22, v22, v135
K1_KCS13:
    s_waitcnt lgkmcnt(0)
    s_waitcnt vmcnt(4)
    v_add_u32 v11, s61, v6
    v_add_u32 v12, s61, v7
    v_add_u32 v13, s61, v8
    v_add_u32 v14, s61, v9
    s_add_u32 s61, s61, 32768
    s_cmp_eq_u32 s61, 98304
    s_cselect_b32 s61, 0, s61
    v_add_u32 v15, 2560, v15
    v_mfma_f32_32x32x16_bf16 v[64:79], v[48:51], v[32:35], v[64:79]
    ds_read_b128 v[24:27], v11
    ds_read_b64_tr_b16 v[40:41], v15 offset:0
    ds_read_b64_tr_b16 v[42:43], v15 offset:160
    v_mfma_f32_32x32x16_bf16 v[80:95], v[32:35], v[52:55], v[80:95]
    ds_read_b64_tr_b16 v[44:45], v15 offset:28672
    ds_read_b64_tr_b16 v[46:47], v15 offset:28832
    s_cmp_eq_u32 s5, 3
    s_cbranch_scc0 K1_KCS14
    v_lshlrev_b32 v132, 16, v48
    v_and_b32 v133, 0xffff0000, v48
    v_add_f32 v21, v21, v132
    v_add_f32 v21, v21, v133
    v_lshlrev_b32 v134, 16, v52
    v_and_b32 v135, 0xffff0000, v52
    v_add_f32 v22, v22, v134
    v_add_f32 v22, v22, v135
    v_lshlrev_b32 v132, 16, v49
    v_and_b32 v133, 0xffff0000, v49
    v_add_f32 v21, v21, v132
    v_add_f32 v21, v21, v133
    v_lshlrev_b32 v134, 16, v53
    v_and_b32 v135, 0xffff0000, v53
    v_add_f32 v22, v22, v134
    v_add_f32 v22, v22, v135
    v_lshlrev_b32 v132, 16, v50
    v_and_b32 v133, 0xffff0000, v50
    v_add_f32 v21, v21, v132
    v_add_f32 v21, v21, v133
    v_lshlrev_b32 v134, 16, v54
    v_and_b32 v135, 0xffff0000, v54
    v_add_f32 v22, v22, v134
    v_add_f32 v22, v22, v135
    v_lshlrev_b32 v132, 16, v51
    v_and_b32 v133, 0xffff0000, v51
    v_add_f32 v21, v21, v132
    v_add_f32 v21, v21, v133
    v_lshlrev_b32 v134, 16, v55
    v_and_b32 v135, 0xffff0000, v55
    v_add_f32 v22, v22, v134
    v_add_f32 v22, v22, v135
K1_KCS14:
    s_xor_b32 s5, s5, s6
    s_waitcnt lgkmcnt(0)
    v_mfma_f32_32x32x16_bf16 v[64:79], v[40:43], v[24:27], v[64:79]
    ds_read_b128 v[32:35], v12
    ds_read_b64_tr_b16 v[48:49], v15 offset:640
    ds_read_b64_tr_b16 v[50:51], v15 offset:800
    v_mfma_f32_32x32x16_bf16 v[80:95], v[24:27], v[44:47], v[80:95]
    ds_read_b64_tr_b16 v[52:53], v15 offset:29312
    ds_read_b64_tr_b16 v[54:55], v15 offset:29472
    s_cmp_eq_u32 s5, 0
    s_cbranch_scc0 K1_KCS15
    v_lshlrev_b32 v132, 16, v40
    v_and_b32 v133, 0xffff0000, v40
    v_add_f32 v21, v21, v132
    v_add_f32 v21, v21, v133
    v_lshlrev_b32 v134, 16, v44
    v_and_b32 v135, 0xffff0000, v44
    v_add_f32 v22, v22, v134
    v_add_f32 v22, v22, v135
    v_lshlrev_b32 v132, 16, v41
    v_and_b32 v133, 0xffff0000, v41
    v_add_f32 v21, v21, v132
    v_add_f32 v21, v21, v133
    v_lshlrev_b32 v134, 16, v45
    v_and_b32 v135, 0xffff0000, v45
    v_add_f32 v22, v22, v134
    v_add_f32 v22, v22, v135
    v_lshlrev_b32 v132, 16, v42
    v_and_b32 v133, 0xffff0000, v42
    v_add_f32 v21, v21, v132
    v_add_f32 v21, v21, v133
    v_lshlrev_b32 v134, 16, v46
    v_and_b32 v135, 0xffff0000, v46
    v_add_f32 v22, v22, v134
    v_add_f32 v22, v22, v135
    v_lshlrev_b32 v132, 16, v43
    v_and_b32 v133, 0xffff0000, v43
    v_add_f32 v21, v21, v132
    v_add_f32 v21, v21, v133
    v_lshlrev_b32 v134, 16, v47
    v_and_b32 v135, 0xffff0000, v47
    v_add_f32 v22, v22, v134
    v_add_f32 v22, v22, v135
K1_KCS15:
    s_waitcnt lgkmcnt(0)
    v_mfma_f32_32x32x16_bf16 v[64:79], v[48:51], v[32:35], v[64:79]
    ds_read_b128 v[24:27], v13
    ds_read_b64_tr_b16 v[40:41], v15 offset:1280
    ds_read_b64_tr_b16 v[42:43], v15 offset:1440
    v_mfma_f32_32x32x16_bf16 v[80:95], v[32:35], v[52:55], v[80:95]
    ds_read_b64_tr_b16 v[44:45], v15 offset:29952
    ds_read_b64_tr_b16 v[46:47], v15 offset:30112
    s_cmp_eq_u32 s5, 1
    s_cbranch_scc0 K1_KCS16
    v_lshlrev_b32 v132, 16, v48
    v_and_b32 v133, 0xffff0000, v48
    v_add_f32 v21, v21, v132
    v_add_f32 v21, v21, v133
    v_lshlrev_b32 v134, 16, v52
    v_and_b32 v135, 0xffff0000, v52
    v_add_f32 v22, v22, v134
    v_add_f32 v22, v22, v135
    v_lshlrev_b32 v132, 16, v49
    v_and_b32 v133, 0xffff0000, v49
    v_add_f32 v21, v21, v132
    v_add_f32 v21, v21, v133
    v_lshlrev_b32 v134, 16, v53
    v_and_b32 v135, 0xffff0000, v53
    v_add_f32 v22, v22, v134
    v_add_f32 v22, v22, v135
    v_lshlrev_b32 v132, 16, v50
    v_and_b32 v133, 0xffff0000, v50
    v_add_f32 v21, v21, v132
    v_add_f32 v21, v21, v133
    v_lshlrev_b32 v134, 16, v54
    v_and_b32 v135, 0xffff0000, v54
    v_add_f32 v22, v22, v134
    v_add_f32 v22, v22, v135
    v_lshlrev_b32 v132, 16, v51
    v_and_b32 v133, 0xffff0000, v51
    v_add_f32 v21, v21, v132
    v_add_f32 v21, v21, v133
    v_lshlrev_b32 v134, 16, v55
    v_and_b32 v135, 0xffff0000, v55
    v_add_f32 v22, v22, v134
    v_add_f32 v22, v22, v135
K1_KCS16:
    s_waitcnt lgkmcnt(0)
    v_mfma_f32_32x32x16_bf16 v[64:79], v[40:43], v[24:27], v[64:79]
    ds_read_b128 v[32:35], v14
    ds_read_b64_tr_b16 v[48:49], v15 offset:1920
    ds_read_b64_tr_b16 v[50:51], v15 offset:2080
    v_mfma_f32_32x32x16_bf16 v[80:95], v[24:27], v[44:47], v[80:95]
    ds_read_b64_tr_b16 v[52:53], v15 offset:30592
    ds_read_b64_tr_b16 v[54:55], v15 offset:30752
    s_cmp_eq_u32 s5, 2
    s_cbranch_scc0 K1_KCS17
    v_lshlrev_b32 v132, 16, v40
    v_and_b32 v133, 0xffff0000, v40
    v_add_f32 v21, v21, v132
    v_add_f32 v21, v21, v133
    v_lshlrev_b32 v134, 16, v44
    v_and_b32 v135, 0xffff0000, v44
    v_add_f32 v22, v22, v134
    v_add_f32 v22, v22, v135
    v_lshlrev_b32 v132, 16, v41
    v_and_b32 v133, 0xffff0000, v41
    v_add_f32 v21, v21, v132
    v_add_f32 v21, v21, v133
    v_lshlrev_b32 v134, 16, v45
    v_and_b32 v135, 0xffff0000, v45
    v_add_f32 v22, v22, v134
    v_add_f32 v22, v22, v135
    v_lshlrev_b32 v132, 16, v42
    v_and_b32 v133, 0xffff0000, v42
    v_add_f32 v21, v21, v132
    v_add_f32 v21, v21, v133
    v_lshlrev_b32 v134, 16, v46
    v_and_b32 v135, 0xffff0000, v46
    v_add_f32 v22, v22, v134
    v_add_f32 v22, v22, v135
    v_lshlrev_b32 v132, 16, v43
    v_and_b32 v133, 0xffff0000, v43
    v_add_f32 v21, v21, v132
    v_add_f32 v21, v21, v133
    v_lshlrev_b32 v134, 16, v47
    v_and_b32 v135, 0xffff0000, v47
    v_add_f32 v22, v22, v134
    v_add_f32 v22, v22, v135
K1_KCS17:
    s_waitcnt lgkmcnt(0)
    s_waitcnt vmcnt(0)
    v_add_u32 v11, s61, v6
    v_add_u32 v12, s61, v7
    v_add_u32 v13, s61, v8
    v_add_u32 v14, s61, v9
    s_add_u32 s61, s61, 32768
    s_cmp_eq_u32 s61, 98304
    s_cselect_b32 s61, 0, s61
    v_add_u32 v15, 2560, v15
    v_mfma_f32_32x32x16_bf16 v[64:79], v[48:51], v[32:35], v[64:79]
    ds_read_b128 v[24:27], v11
    ds_read_b64_tr_b16 v[40:41], v15 offset:0
    ds_read_b64_tr_b16 v[42:43], v15 offset:160
    v_mfma_f32_32x32x16_bf16 v[80:95], v[32:35], v[52:55], v[80:95]
    ds_read_b64_tr_b16 v[44:45], v15 offset:28672
    ds_read_b64_tr_b16 v[46:47], v15 offset:28832
    s_cmp_eq_u32 s5, 3
    s_cbranch_scc0 K1_KCS18
    v_lshlrev_b32 v132, 16, v48
    v_and_b32 v133, 0xffff0000, v48
    v_add_f32 v21, v21, v132
    v_add_f32 v21, v21, v133
    v_lshlrev_b32 v134, 16, v52
    v_and_b32 v135, 0xffff0000, v52
    v_add_f32 v22, v22, v134
    v_add_f32 v22, v22, v135
    v_lshlrev_b32 v132, 16, v49
    v_and_b32 v133, 0xffff0000, v49
    v_add_f32 v21, v21, v132
    v_add_f32 v21, v21, v133
    v_lshlrev_b32 v134, 16, v53
    v_and_b32 v135, 0xffff0000, v53
    v_add_f32 v22, v22, v134
    v_add_f32 v22, v22, v135
    v_lshlrev_b32 v132, 16, v50
    v_and_b32 v133, 0xffff0000, v50
    v_add_f32 v21, v21, v132
    v_add_f32 v21, v21, v133
    v_lshlrev_b32 v134, 16, v54
    v_and_b32 v135, 0xffff0000, v54
    v_add_f32 v22, v22, v134
    v_add_f32 v22, v22, v135
    v_lshlrev_b32 v132, 16, v51
    v_and_b32 v133, 0xffff0000, v51
    v_add_f32 v21, v21, v132
    v_add_f32 v21, v21, v133
    v_lshlrev_b32 v134, 16, v55
    v_and_b32 v135, 0xffff0000, v55
    v_add_f32 v22, v22, v134
    v_add_f32 v22, v22, v135
K1_KCS18:
    s_xor_b32 s5, s5, s6
    s_waitcnt lgkmcnt(0)
    v_mfma_f32_32x32x16_bf16 v[64:79], v[40:43], v[24:27], v[64:79]
    ds_read_b128 v[32:35], v12
    ds_read_b64_tr_b16 v[48:49], v15 offset:640
    ds_read_b64_tr_b16 v[50:51], v15 offset:800
    v_mfma_f32_32x32x16_bf16 v[80:95], v[24:27], v[44:47], v[80:95]
    ds_read_b64_tr_b16 v[52:53], v15 offset:29312
    ds_read_b64_tr_b16 v[54:55], v15 offset:29472
    s_cmp_eq_u32 s5, 0
    s_cbranch_scc0 K1_KCS19
    v_lshlrev_b32 v132, 16, v40
    v_and_b32 v133, 0xffff0000, v40
    v_add_f32 v21, v21, v132
    v_add_f32 v21, v21, v133
    v_lshlrev_b32 v134, 16, v44
    v_and_b32 v135, 0xffff0000, v44
    v_add_f32 v22, v22, v134
    v_add_f32 v22, v22, v135
    v_lshlrev_b32 v132, 16, v41
    v_and_b32 v133, 0xffff0000, v41
    v_add_f32 v21, v21, v132
    v_add_f32 v21, v21, v133
    v_lshlrev_b32 v134, 16, v45
    v_and_b32 v135, 0xffff0000, v45
    v_add_f32 v22, v22, v134
    v_add_f32 v22, v22, v135
    v_lshlrev_b32 v132, 16, v42
    v_and_b32 v133, 0xffff0000, v42
    v_add_f32 v21, v21, v132
    v_add_f32 v21, v21, v133
    v_lshlrev_b32 v134, 16, v46
    v_and_b32 v135, 0xffff0000, v46
    v_add_f32 v22, v22, v134
    v_add_f32 v22, v22, v135
    v_lshlrev_b32 v132, 16, v43
    v_and_b32 v133, 0xffff0000, v43
    v_add_f32 v21, v21, v132
    v_add_f32 v21, v21, v133
    v_lshlrev_b32 v134, 16, v47
    v_and_b32 v135, 0xffff0000, v47
    v_add_f32 v22, v22, v134
    v_add_f32 v22, v22, v135
K1_KCS19:
    s_waitcnt lgkmcnt(0)
    v_mfma_f32_32x32x16_bf16 v[64:79], v[48:51], v[32:35], v[64:79]
    ds_read_b128 v[24:27], v13
    ds_read_b64_tr_b16 v[40:41], v15 offset:1280
    ds_read_b64_tr_b16 v[42:43], v15 offset:1440
    v_mfma_f32_32x32x16_bf16 v[80:95], v[32:35], v[52:55], v[80:95]
    ds_read_b64_tr_b16 v[44:45], v15 offset:29952
    ds_read_b64_tr_b16 v[46:47], v15 offset:30112
    s_cmp_eq_u32 s5, 1
    s_cbranch_scc0 K1_KCS20
    v_lshlrev_b32 v132, 16, v48
    v_and_b32 v133, 0xffff0000, v48
    v_add_f32 v21, v21, v132
    v_add_f32 v21, v21, v133
    v_lshlrev_b32 v134, 16, v52
    v_and_b32 v135, 0xffff0000, v52
    v_add_f32 v22, v22, v134
    v_add_f32 v22, v22, v135
    v_lshlrev_b32 v132, 16, v49
    v_and_b32 v133, 0xffff0000, v49
    v_add_f32 v21, v21, v132
    v_add_f32 v21, v21, v133
    v_lshlrev_b32 v134, 16, v53
    v_and_b32 v135, 0xffff0000, v53
    v_add_f32 v22, v22, v134
    v_add_f32 v22, v22, v135
    v_lshlrev_b32 v132, 16, v50
    v_and_b32 v133, 0xffff0000, v50
    v_add_f32 v21, v21, v132
    v_add_f32 v21, v21, v133
    v_lshlrev_b32 v134, 16, v54
    v_and_b32 v135, 0xffff0000, v54
    v_add_f32 v22, v22, v134
    v_add_f32 v22, v22, v135
    v_lshlrev_b32 v132, 16, v51
    v_and_b32 v133, 0xffff0000, v51
    v_add_f32 v21, v21, v132
    v_add_f32 v21, v21, v133
    v_lshlrev_b32 v134, 16, v55
    v_and_b32 v135, 0xffff0000, v55
    v_add_f32 v22, v22, v134
    v_add_f32 v22, v22, v135
K1_KCS20:
    s_waitcnt lgkmcnt(0)
    v_mfma_f32_32x32x16_bf16 v[64:79], v[40:43], v[24:27], v[64:79]
    ds_read_b128 v[32:35], v14
    ds_read_b64_tr_b16 v[48:49], v15 offset:1920
    ds_read_b64_tr_b16 v[50:51], v15 offset:2080
    v_mfma_f32_32x32x16_bf16 v[80:95], v[24:27], v[44:47], v[80:95]
    ds_read_b64_tr_b16 v[52:53], v15 offset:30592
    ds_read_b64_tr_b16 v[54:55], v15 offset:30752
    s_cmp_eq_u32 s5, 2
    s_cbranch_scc0 K1_KCS21
    v_lshlrev_b32 v132, 16, v40
    v_and_b32 v133, 0xffff0000, v40
    v_add_f32 v21, v21, v132
    v_add_f32 v21, v21, v133
    v_lshlrev_b32 v134, 16, v44
    v_and_b32 v135, 0xffff0000, v44
    v_add_f32 v22, v22, v134
    v_add_f32 v22, v22, v135
    v_lshlrev_b32 v132, 16, v41
    v_and_b32 v133, 0xffff0000, v41
    v_add_f32 v21, v21, v132
    v_add_f32 v21, v21, v133
    v_lshlrev_b32 v134, 16, v45
    v_and_b32 v135, 0xffff0000, v45
    v_add_f32 v22, v22, v134
    v_add_f32 v22, v22, v135
    v_lshlrev_b32 v132, 16, v42
    v_and_b32 v133, 0xffff0000, v42
    v_add_f32 v21, v21, v132
    v_add_f32 v21, v21, v133
    v_lshlrev_b32 v134, 16, v46
    v_and_b32 v135, 0xffff0000, v46
    v_add_f32 v22, v22, v134
    v_add_f32 v22, v22, v135
    v_lshlrev_b32 v132, 16, v43
    v_and_b32 v133, 0xffff0000, v43
    v_add_f32 v21, v21, v132
    v_add_f32 v21, v21, v133
    v_lshlrev_b32 v134, 16, v47
    v_and_b32 v135, 0xffff0000, v47
    v_add_f32 v22, v22, v134
    v_add_f32 v22, v22, v135
K1_KCS21:
    s_waitcnt lgkmcnt(0)
    v_mfma_f32_32x32x16_bf16 v[64:79], v[48:51], v[32:35], v[64:79]
    v_mfma_f32_32x32x16_bf16 v[80:95], v[32:35], v[52:55], v[80:95]
    s_cmp_eq_u32 s5, 3
    s_cbranch_scc0 K1_KCS22
    v_lshlrev_b32 v132, 16, v48
    v_and_b32 v133, 0xffff0000, v48
    v_add_f32 v21, v21, v132
    v_add_f32 v21, v21, v133
    v_lshlrev_b32 v134, 16, v52
    v_and_b32 v135, 0xffff0000, v52
    v_add_f32 v22, v22, v134
    v_add_f32 v22, v22, v135
    v_lshlrev_b32 v132, 16, v49
    v_and_b32 v133, 0xffff0000, v49
    v_add_f32 v21, v21, v132
    v_add_f32 v21, v21, v133
    v_lshlrev_b32 v134, 16, v53
    v_and_b32 v135, 0xffff0000, v53
    v_add_f32 v22, v22, v134
    v_add_f32 v22, v22, v135
    v_lshlrev_b32 v132, 16, v50
    v_and_b32 v133, 0xffff0000, v50
    v_add_f32 v21, v21, v132
    v_add_f32 v21, v21, v133
    v_lshlrev_b32 v134, 16, v54
    v_and_b32 v135, 0xffff0000, v54
    v_add_f32 v22, v22, v134
    v_add_f32 v22, v22, v135
    v_lshlrev_b32 v132, 16, v51
    v_and_b32 v133, 0xffff0000, v51
    v_add_f32 v21, v21, v132
    v_add_f32 v21, v21, v133
    v_lshlrev_b32 v134, 16, v55
    v_and_b32 v135, 0xffff0000, v55
    v_add_f32 v22, v22, v134
    v_add_f32 v22, v22, v135
K1_KCS22:
    s_xor_b32 s5, s5, s6
    v_and_b32 v24, 31, v0
    v_lshlrev_b32 v26, 6, v24
    v_lshrrev_b32 v27, 5, v0
    s_lshl_b32 s67, s52, 1
    v_add_u32 v27, s67, v27
    v_lshl_add_u32 v27, v27, 2, v26
    s_mov_b32 s27, 19880960
    s_cmp_lg_u32 s52, 0
    s_cbranch_scc1 K1_KVPOK
K1_KVP:
    buffer_load_dwordx4 v[160:163], v16, s[48:51], s27 offen sc1
    s_waitcnt vmcnt(0)
    v_xor_b32 v160, s3, v160
    v_xor_b32 v161, s3, v161
    v_xor_b32 v162, s3, v162
    v_xor_b32 v163, s3, v163
    v_or3_b32 v160, v160, v161, v162
    v_or_b32 v160, v160, v163
    v_cmp_eq_u32 vcc, 0, v160
    s_nop 3
    s_cmp_eq_u64 vcc, exec
    s_cbranch_scc1 K1_KVPOK
    s_sleep 2
    s_branch K1_KVP
K1_KVPOK:
    s_waitcnt lgkmcnt(0)
    s_barrier
    s_lshl_b32 s63, s55, 8
    s_lshl_b32 s67, s52, 5
    s_add_u32 s63, s63, s67
    v_add_u32 v25, s63, v24
    v_lshlrev_b32 v25, 3, v25
    buffer_load_dwordx2 v[60:61], v25, s[48:51], s76 offen sc1
    s_lshl_b32 s63, s52, 7
    s_add_u32 s63, s63, 155648
    v_lshlrev_b32 v25, 2, v24
    v_add_u32 v25, s63, v25
    ds_write_b32 v27, v21
    ds_write_b32 v27, v22 offset:2048
    s_waitcnt lgkmcnt(0)
    s_barrier
    ds_read_b128 v[112:115], v26 offset:0
    ds_read_b128 v[116:119], v26 offset:16
    ds_read_b128 v[120:123], v26 offset:32
    ds_read_b128 v[124:127], v26 offset:48
    ds_read_b128 v[128:131], v26 offset:2048
    ds_read_b128 v[132:135], v26 offset:2064
    ds_read_b128 v[136:139], v26 offset:2080
    ds_read_b128 v[140:143], v26 offset:2096
    s_waitcnt lgkmcnt(0)
    v_add_f32 v112, v112, v113
    v_add_f32 v114, v114, v115
    v_add_f32 v116, v116, v117
    v_add_f32 v118, v118, v119
    v_add_f32 v120, v120, v121
    v_add_f32 v122, v122, v123
    v_add_f32 v124, v124, v125
    v_add_f32 v126, v126, v127
    v_add_f32 v112, v112, v114
    v_add_f32 v116, v116, v118
    v_add_f32 v120, v120, v122
    v_add_f32 v124, v124, v126
    v_add_f32 v112, v112, v116
    v_add_f32 v120, v120, v124
    v_add_f32 v112, v112, v120
    v_mov_b32 v21, v112
    v_add_f32 v128, v128, v129
    v_add_f32 v130, v130, v131
    v_add_f32 v132, v132, v133
    v_add_f32 v134, v134, v135
    v_add_f32 v136, v136, v137
    v_add_f32 v138, v138, v139
    v_add_f32 v140, v140, v141
    v_add_f32 v142, v142, v143
    v_add_f32 v128, v128, v130
    v_add_f32 v132, v132, v134
    v_add_f32 v136, v136, v138
    v_add_f32 v140, v140, v142
    v_add_f32 v128, v128, v132
    v_add_f32 v136, v136, v140
    v_add_f32 v128, v128, v136
    v_mov_b32 v22, v128
    s_waitcnt vmcnt(0)
    ds_write_b32 v25, v61
    v_cmp_gt_u32 vcc, 32, v0
    s_nop 1
    v_cndmask_b32 v44, 0, v60, vcc
    v_and_b32 v45, 0xffff, v44
    v_mov_b32 v46, 0
    v_mov_b32 v47, 0
    v_cvt_pk_bf16_f32 v26, v21, v21
    v_lshlrev_b32 v27, 16, v26
    v_sub_f32 v21, v21, v27
    v_cvt_pk_bf16_f32 v48, v21, v21
    v_lshlrev_b32 v27, 16, v48
    v_sub_f32 v21, v21, v27
    v_and_b32 v26, 0xffff, v26
    v_or_b32 v48, v26, v27
    v_cvt_pk_bf16_f32 v49, v21, 0
    v_mov_b32 v50, 0
    v_mov_b32 v51, 0
    v_cvt_pk_bf16_f32 v26, v22, v22
    v_lshlrev_b32 v27, 16, v26
    v_sub_f32 v22, v22, v27
    v_cvt_pk_bf16_f32 v52, v22, v22
    v_lshlrev_b32 v27, 16, v52
    v_sub_f32 v22, v22, v27
    v_and_b32 v26, 0xffff, v26
    v_or_b32 v52, v26, v27
    v_cvt_pk_bf16_f32 v53, v22, 0
    v_mov_b32 v54, 0
    v_mov_b32 v55, 0
    v_mfma_f32_32x32x16_bf16 v[64:79], v[48:51], v[44:47], v[64:79]
    s_nop 0
    v_mfma_f32_32x32x16_bf16 v[80:95], v[44:47], v[52:55], v[80:95]
    v_lshrrev_b32 v26, 5, v0
    v_lshlrev_b32 v26, 4, v26
    v_add_u32 v26, s63, v26
    s_waitcnt lgkmcnt(0)
    ds_read_b128 v[28:31], v26 offset:0
    ds_read_b128 v[32:35], v26 offset:32
    ds_read_b128 v[36:39], v26 offset:64
    ds_read_b128 v[40:43], v26 offset:96
    s_lshl_b32 s4, s55, 3
    s_add_u32 s4, s4, s52
    s_mul_i32 s5, s4, 2624
    s_add_u32 s5, s5, 8912896
    v_mul_f32 v64, v61, v64
    v_mul_f32 v65, v61, v65
    v_mul_f32 v66, v61, v66
    v_mul_f32 v67, v61, v67
    v_mul_f32 v68, v61, v68
    v_mul_f32 v69, v61, v69
    v_mul_f32 v70, v61, v70
    v_mul_f32 v71, v61, v71
    v_mul_f32 v72, v61, v72
    v_mul_f32 v73, v61, v73
    v_mul_f32 v74, v61, v74
    v_mul_f32 v75, v61, v75
    v_cvt_pk_bf16_f32 v96, v64, v65
    v_cvt_pk_bf16_f32 v97, v66, v67
    v_cvt_pk_bf16_f32 v98, v68, v69
    v_cvt_pk_bf16_f32 v99, v70, v71
    v_cvt_pk_bf16_f32 v100, v72, v73
    v_cvt_pk_bf16_f32 v101, v74, v75
    buffer_store_dwordx4 v[96:99], v16, s[48:51], s5 offen sc0 sc1
    v_cndmask_b32 v100, 0, v100, vcc
    v_cndmask_b32 v101, 0, v101, vcc
    v_mov_b32 v102, 0
    v_dot2_f32_bf16 v102, v96, v96, v102
    v_dot2_f32_bf16 v102, v97, v97, v102
    v_dot2_f32_bf16 v102, v98, v98, v102
    v_dot2_f32_bf16 v102, v99, v99, v102
    v_dot2_f32_bf16 v102, v100, v100, v102
    v_dot2_f32_bf16 v102, v101, v101, v102
    v_lshlrev_b32 v27, 3, v0
    s_and_saveexec_b64 s[78:79], vcc
    buffer_store_dwordx2 v[100:101], v27, s[48:51], s5 offen offset:1024 sc0 sc1
    s_mov_b64 exec, s[78:79]
    v_mov_b32 v103, v102
    s_nop 1
    v_permlane32_swap_b32 v102, v103
    v_add_f32 v102, v102, v103
    s_waitcnt lgkmcnt(0)
    ds_swizzle_b32 v103, v102 offset:0x041f
    s_waitcnt lgkmcnt(0)
    v_max_f32 v102, v102, v103
    ds_swizzle_b32 v103, v102 offset:0x081f
    s_waitcnt lgkmcnt(0)
    v_max_f32 v102, v102, v103
    ds_swizzle_b32 v103, v102 offset:0x101f
    s_waitcnt lgkmcnt(0)
    v_max_f32 v102, v102, v103
    ds_swizzle_b32 v103, v102 offset:0x201f
    s_waitcnt lgkmcnt(0)
    v_max_f32 v102, v102, v103
    ds_swizzle_b32 v103, v102 offset:0x401f
    s_waitcnt lgkmcnt(0)
    v_max_f32 v102, v102, v103
    s_lshl_b32 s6, s4, 2
    s_add_u32 s6, s6, 9080832
    v_mov_b32 v104, 0
    v_cmp_eq_u32 vcc, 0, v0
    s_nop 0
    s_and_saveexec_b64 s[78:79], vcc
    buffer_store_dword v102, v104, s[48:51], s6 offen sc0 sc1
    s_mov_b64 exec, s[78:79]
    v_mul_f32 v80, v28, v80
    v_mul_f32 v81, v29, v81
    v_mul_f32 v82, v30, v82
    v_mul_f32 v83, v31, v83
    v_mul_f32 v84, v32, v84
    v_mul_f32 v85, v33, v85
    v_mul_f32 v86, v34, v86
    v_mul_f32 v87, v35, v87
    v_mul_f32 v88, v36, v88
    v_mul_f32 v89, v37, v89
    v_mul_f32 v90, v38, v90
    v_mul_f32 v91, v39, v91
    v_mul_f32 v92, v40, v92
    v_mul_f32 v93, v41, v93
    v_mul_f32 v94, v42, v94
    v_mul_f32 v95, v43, v95
    v_cvt_pk_bf16_f32 v104, v80, v81
    v_cvt_pk_bf16_f32 v105, v82, v83
    v_cvt_pk_bf16_f32 v106, v84, v85
    v_cvt_pk_bf16_f32 v107, v86, v87
    v_cvt_pk_bf16_f32 v108, v88, v89
    v_cvt_pk_bf16_f32 v109, v90, v91
    v_cvt_pk_bf16_f32 v110, v92, v93
    v_cvt_pk_bf16_f32 v111, v94, v95
    v_lshrrev_b32 v26, 5, v0
    v_mul_u32_u24 v26, 336, v26
    v_lshl_add_u32 v26, v24, 4, v26
    v_cmp_gt_u32 vcc, 32, v0
    v_mov_b32 v27, 0x3f803f80
    s_nop 0
    v_cndmask_b32 v27, 0, v27, vcc
    v_cmp_gt_u32 vcc, 20, v24
    s_nop 1
    v_cndmask_b32 v104, v27, v104, vcc
    v_cndmask_b32 v105, v27, v105, vcc
    v_cndmask_b32 v106, v27, v106, vcc
    v_cndmask_b32 v107, v27, v107, vcc
    v_cndmask_b32 v108, v27, v108, vcc
    v_cndmask_b32 v109, v27, v109, vcc
    v_cndmask_b32 v110, v27, v110, vcc
    v_cndmask_b32 v111, v27, v111, vcc
    v_cmp_gt_u32 vcc, 21, v24
    s_nop 0
    s_and_saveexec_b64 s[78:79], vcc
    buffer_store_dwordx4 v[104:107], v26, s[48:51], s5 offen offset:1280 sc0 sc1
    buffer_store_dwordx4 v[108:111], v26, s[48:51], s5 offen offset:1952 sc0 sc1
    s_mov_b64 exec, s[78:79]
    s_branch K1_ENDL
K1_RELAY:
    s_sub_u32 s70, s56, 30
    s_lshl_b32 s70, s70, 3
    s_add_u32 s70, s70, s55
    s_lshl_b32 s70, s70, 1
    s_add_u32 s70, s70, s54
    s_mul_i32 s69, s53, 320
    v_add_u32 v10, 0, v0
    v_mul_u32_u24 v11, 3277, v10
    v_lshrrev_b32 v11, 16, v11
    v_mul_u32_u24 v12, 20, v11
    v_sub_u32 v12, v10, v12
    v_lshlrev_b32 v12, 4, v12
    v_add_u32 v12, s69, v12
    v_mul_u32_u24 v13, 1280, v11
    v_add_u32 v60, v13, v12
    v_lshrrev_b32 v13, 3, v11
    v_mul_u32_u24 v13, 80, v13
    v_bfe_u32 v14, v11, 2, 1
    v_mul_u32_u24 v14, 20, v14
    v_and_b32 v15, 3, v11
    v_add3_u32 v13, v13, v14, v15
    v_mul_u32_u24 v13, 1280, v13
    v_add_u32 v65, v13, v12
    v_add_u32 v10, 64, v0
    v_mul_u32_u24 v11, 3277, v10
    v_lshrrev_b32 v11, 16, v11
    v_mul_u32_u24 v12, 20, v11
    v_sub_u32 v12, v10, v12
    v_lshlrev_b32 v12, 4, v12
    v_add_u32 v12, s69, v12
    v_mul_u32_u24 v13, 1280, v11
    v_add_u32 v61, v13, v12
    v_lshrrev_b32 v13, 3, v11
    v_mul_u32_u24 v13, 80, v13
    v_bfe_u32 v14, v11, 2, 1
    v_mul_u32_u24 v14, 20, v14
    v_and_b32 v15, 3, v11
    v_add3_u32 v13, v13, v14, v15
    v_mul_u32_u24 v13, 1280, v13
    v_add_u32 v66, v13, v12
    v_add_u32 v10, 128, v0
    v_mul_u32_u24 v11, 3277, v10
    v_lshrrev_b32 v11, 16, v11
    v_mul_u32_u24 v12, 20, v11
    v_sub_u32 v12, v10, v12
    v_lshlrev_b32 v12, 4, v12
    v_add_u32 v12, s69, v12
    v_mul_u32_u24 v13, 1280, v11
    v_add_u32 v62, v13, v12
    v_lshrrev_b32 v13, 3, v11
    v_mul_u32_u24 v13, 80, v13
    v_bfe_u32 v14, v11, 2, 1
    v_mul_u32_u24 v14, 20, v14
    v_and_b32 v15, 3, v11
    v_add3_u32 v13, v13, v14, v15
    v_mul_u32_u24 v13, 1280, v13
    v_add_u32 v67, v13, v12
    v_add_u32 v10, 192, v0
    v_mul_u32_u24 v11, 3277, v10
    v_lshrrev_b32 v11, 16, v11
    v_mul_u32_u24 v12, 20, v11
    v_sub_u32 v12, v10, v12
    v_lshlrev_b32 v12, 4, v12
    v_add_u32 v12, s69, v12
    v_mul_u32_u24 v13, 1280, v11
    v_add_u32 v63, v13, v12
    v_lshrrev_b32 v13, 3, v11
    v_mul_u32_u24 v13, 80, v13
    v_bfe_u32 v14, v11, 2, 1
    v_mul_u32_u24 v14, 20, v14
    v_and_b32 v15, 3, v11
    v_add3_u32 v13, v13, v14, v15
    v_mul_u32_u24 v13, 1280, v13
    v_add_u32 v68, v13, v12
    v_add_u32 v10, 256, v0
    v_mul_u32_u24 v11, 3277, v10
    v_lshrrev_b32 v11, 16, v11
    v_mul_u32_u24 v12, 20, v11
    v_sub_u32 v12, v10, v12
    v_lshlrev_b32 v12, 4, v12
    v_add_u32 v12, s69, v12
    v_mul_u32_u24 v13, 1280, v11
    v_add_u32 v64, v13, v12
    v_lshrrev_b32 v13, 3, v11
    v_mul_u32_u24 v13, 80, v13
    v_bfe_u32 v14, v11, 2, 1
    v_mul_u32_u24 v14, 20, v14
    v_and_b32 v15, 3, v11
    v_add3_u32 v13, v13, v14, v15
    v_mul_u32_u24 v13, 1280, v13
    v_add_u32 v69, v13, v12
    s_mul_i32 s65, s52, 15360
    v_lshrrev_b32 v11, 5, v0
    v_and_b32 v12, 15, v0
    v_lshrrev_b32 v13, 2, v12
    v_and_b32 v12, 3, v12
    v_lshl_add_u32 v14, v11, 2, v13
    v_mul_u32_u24 v14, 320, v14
    v_lshrrev_b32 v15, 4, v0
    v_and_b32 v15, 1, v15
    v_lshl_add_u32 v14, v15, 5, v14
    v_lshl_add_u32 v14, v12, 3, v14
    v_add_u32 v30, s65, v14
    s_add_u32 s4, s70, 0
    s_add_u32 s6, s65, 0
    s_cmp_ge_u32 s4, 96
    s_cbranch_scc1 K1_RI_WO0
    s_mov_b32 s40, s32
    s_mov_b32 s41, s33
    s_mov_b32 s42, 1966080
    s_mov_b32 s43, 0x00020000
    s_mul_i32 s5, s4, 20480
    s_branch K1_RI_REG0
K1_RI_WO0:
    s_mov_b32 s40, s24
    s_mov_b32 s41, s25
    s_mov_b32 s42, 819200
    s_mov_b32 s43, 0x00020000
    s_sub_u32 s4, s4, 96
    s_mul_i32 s5, s4, 25600
    s_cmp_lt_u32 s4, 32
    s_cbranch_scc1 K1_RI_REG0
    s_sub_u32 s4, s4, 32
    s_lshr_b32 s5, s4, 1
    s_lshl_b32 s5, s5, 3
    s_and_b32 s4, s4, 1
    s_lshl_b32 s4, s4, 1
    s_add_u32 s5, s5, s4
    s_mul_i32 s5, s5, 20
    s_add_u32 s5, s5, 16
    s_mul_i32 s5, s5, 1280
    s_add_u32 m0, s6, 0
    s_nop 0
    buffer_load_dwordx4 v65, s[40:43], s5 offen  lds
    s_add_u32 m0, s6, 1024
    s_nop 0
    buffer_load_dwordx4 v66, s[40:43], s5 offen  lds
    s_add_u32 m0, s6, 2048
    s_nop 0
    buffer_load_dwordx4 v67, s[40:43], s5 offen  lds
    s_add_u32 m0, s6, 3072
    s_nop 0
    buffer_load_dwordx4 v68, s[40:43], s5 offen  lds
    s_add_u32 m0, s6, 4096
    s_nop 0
    buffer_load_dwordx4 v69, s[40:43], s5 offen  lds
    s_branch K1_RI_DONE0
K1_RI_REG0:
    s_add_u32 m0, s6, 0
    s_nop 0
    buffer_load_dwordx4 v60, s[40:43], s5 offen  lds
    s_add_u32 m0, s6, 1024
    s_nop 0
    buffer_load_dwordx4 v61, s[40:43], s5 offen  lds
    s_add_u32 m0, s6, 2048
    s_nop 0
    buffer_load_dwordx4 v62, s[40:43], s5 offen  lds
    s_add_u32 m0, s6, 3072
    s_nop 0
    buffer_load_dwordx4 v63, s[40:43], s5 offen  lds
    s_add_u32 m0, s6, 4096
    s_nop 0
    buffer_load_dwordx4 v64, s[40:43], s5 offen  lds
K1_RI_DONE0:
    s_add_u32 s4, s70, 32
    s_add_u32 s6, s65, 5120
    s_cmp_ge_u32 s4, 96
    s_cbranch_scc1 K1_RI_WO1
    s_mov_b32 s40, s32
    s_mov_b32 s41, s33
    s_mov_b32 s42, 1966080
    s_mov_b32 s43, 0x00020000
    s_mul_i32 s5, s4, 20480
    s_branch K1_RI_REG1
K1_RI_WO1:
    s_mov_b32 s40, s24
    s_mov_b32 s41, s25
    s_mov_b32 s42, 819200
    s_mov_b32 s43, 0x00020000
    s_sub_u32 s4, s4, 96
    s_mul_i32 s5, s4, 25600
    s_cmp_lt_u32 s4, 32
    s_cbranch_scc1 K1_RI_REG1
    s_sub_u32 s4, s4, 32
    s_lshr_b32 s5, s4, 1
    s_lshl_b32 s5, s5, 3
    s_and_b32 s4, s4, 1
    s_lshl_b32 s4, s4, 1
    s_add_u32 s5, s5, s4
    s_mul_i32 s5, s5, 20
    s_add_u32 s5, s5, 16
    s_mul_i32 s5, s5, 1280
    s_add_u32 m0, s6, 0
    s_nop 0
    buffer_load_dwordx4 v65, s[40:43], s5 offen  lds
    s_add_u32 m0, s6, 1024
    s_nop 0
    buffer_load_dwordx4 v66, s[40:43], s5 offen  lds
    s_add_u32 m0, s6, 2048
    s_nop 0
    buffer_load_dwordx4 v67, s[40:43], s5 offen  lds
    s_add_u32 m0, s6, 3072
    s_nop 0
    buffer_load_dwordx4 v68, s[40:43], s5 offen  lds
    s_add_u32 m0, s6, 4096
    s_nop 0
    buffer_load_dwordx4 v69, s[40:43], s5 offen  lds
    s_branch K1_RI_DONE1
K1_RI_REG1:
    s_add_u32 m0, s6, 0
    s_nop 0
    buffer_load_dwordx4 v60, s[40:43], s5 offen  lds
    s_add_u32 m0, s6, 1024
    s_nop 0
    buffer_load_dwordx4 v61, s[40:43], s5 offen  lds
    s_add_u32 m0, s6, 2048
    s_nop 0
    buffer_load_dwordx4 v62, s[40:43], s5 offen  lds
    s_add_u32 m0, s6, 3072
    s_nop 0
    buffer_load_dwordx4 v63, s[40:43], s5 offen  lds
    s_add_u32 m0, s6, 4096
    s_nop 0
    buffer_load_dwordx4 v64, s[40:43], s5 offen  lds
K1_RI_DONE1:
    s_add_u32 s4, s70, 64
    s_add_u32 s6, s65, 10240
    s_cmp_ge_u32 s4, 96
    s_cbranch_scc1 K1_RI_WO2
    s_mov_b32 s40, s32
    s_mov_b32 s41, s33
    s_mov_b32 s42, 1966080
    s_mov_b32 s43, 0x00020000
    s_mul_i32 s5, s4, 20480
    s_branch K1_RI_REG2
K1_RI_WO2:
    s_mov_b32 s40, s24
    s_mov_b32 s41, s25
    s_mov_b32 s42, 819200
    s_mov_b32 s43, 0x00020000
    s_sub_u32 s4, s4, 96
    s_mul_i32 s5, s4, 25600
    s_cmp_lt_u32 s4, 32
    s_cbranch_scc1 K1_RI_REG2
    s_sub_u32 s4, s4, 32
    s_lshr_b32 s5, s4, 1
    s_lshl_b32 s5, s5, 3
    s_and_b32 s4, s4, 1
    s_lshl_b32 s4, s4, 1
    s_add_u32 s5, s5, s4
    s_mul_i32 s5, s5, 20
    s_add_u32 s5, s5, 16
    s_mul_i32 s5, s5, 1280
    s_add_u32 m0, s6, 0
    s_nop 0
    buffer_load_dwordx4 v65, s[40:43], s5 offen  lds
    s_add_u32 m0, s6, 1024
    s_nop 0
    buffer_load_dwordx4 v66, s[40:43], s5 offen  lds
    s_add_u32 m0, s6, 2048
    s_nop 0
    buffer_load_dwordx4 v67, s[40:43], s5 offen  lds
    s_add_u32 m0, s6, 3072
    s_nop 0
    buffer_load_dwordx4 v68, s[40:43], s5 offen  lds
    s_add_u32 m0, s6, 4096
    s_nop 0
    buffer_load_dwordx4 v69, s[40:43], s5 offen  lds
    s_branch K1_RI_DONE2
K1_RI_REG2:
    s_add_u32 m0, s6, 0
    s_nop 0
    buffer_load_dwordx4 v60, s[40:43], s5 offen  lds
    s_add_u32 m0, s6, 1024
    s_nop 0
    buffer_load_dwordx4 v61, s[40:43], s5 offen  lds
    s_add_u32 m0, s6, 2048
    s_nop 0
    buffer_load_dwordx4 v62, s[40:43], s5 offen  lds
    s_add_u32 m0, s6, 3072
    s_nop 0
    buffer_load_dwordx4 v63, s[40:43], s5 offen  lds
    s_add_u32 m0, s6, 4096
    s_nop 0
    buffer_load_dwordx4 v64, s[40:43], s5 offen  lds
K1_RI_DONE2:
    s_lshl_b32 s63, s55, 8
    s_lshl_b32 s67, s56, 3
    s_add_u32 s63, s63, s67
    s_add_u32 s63, s63, s52
    v_mov_b32 v23, s63
    s_mul_i32 s63, s63, 1280
    v_lshlrev_b32 v128, 5, v0
    v_mov_b32 v129, 0x7f000000
    v_cmp_gt_u32 vcc, 40, v0
    s_nop 1
    v_cndmask_b32 v128, v129, v128, vcc
    buffer_load_dwordx4 v[136:139], v128, s[36:39], s63 offen offset:0
    buffer_load_dwordx4 v[140:143], v128, s[36:39], s63 offen offset:16
    s_waitcnt vmcnt(0)
    v_dot2_f32_bf16 v17, v136, s66, v17
    v_dot2_f32_bf16 v19, v136, v136, v19
    v_dot2_f32_bf16 v18, v137, s66, v18
    v_dot2_f32_bf16 v20, v137, v137, v20
    v_dot2_f32_bf16 v17, v138, s66, v17
    v_dot2_f32_bf16 v19, v138, v138, v19
    v_dot2_f32_bf16 v18, v139, s66, v18
    v_dot2_f32_bf16 v20, v139, v139, v20
    v_dot2_f32_bf16 v17, v140, s66, v17
    v_dot2_f32_bf16 v19, v140, v140, v19
    v_dot2_f32_bf16 v18, v141, s66, v18
    v_dot2_f32_bf16 v20, v141, v141, v20
    v_dot2_f32_bf16 v17, v142, s66, v17
    v_dot2_f32_bf16 v19, v142, v142, v19
    v_dot2_f32_bf16 v18, v143, s66, v18
    v_dot2_f32_bf16 v20, v143, v143, v20
    s_nop 1
    v_add_f32 v17, v17, v18
    v_add_f32 v19, v19, v20
    s_nop 0
    v_add_f32_dpp v17, v17, v17 row_ror:8 row_mask:0xf bank_mask:0xf
    v_add_f32_dpp v19, v19, v19 row_ror:8 row_mask:0xf bank_mask:0xf
    s_nop 0
    v_add_f32_dpp v17, v17, v17 row_ror:4 row_mask:0xf bank_mask:0xf
    v_add_f32_dpp v19, v19, v19 row_ror:4 row_mask:0xf bank_mask:0xf
    s_nop 0
    v_add_f32_dpp v17, v17, v17 row_ror:2 row_mask:0xf bank_mask:0xf
    v_add_f32_dpp v19, v19, v19 row_ror:2 row_mask:0xf bank_mask:0xf
    s_nop 0
    v_add_f32_dpp v17, v17, v17 row_ror:1 row_mask:0xf bank_mask:0xf
    v_add_f32_dpp v19, v19, v19 row_ror:1 row_mask:0xf bank_mask:0xf
    s_nop 0
    v_add_f32_dpp v17, v17, v17 row_bcast:15 row_mask:0xa bank_mask:0xf
    v_add_f32_dpp v19, v19, v19 row_bcast:15 row_mask:0xa bank_mask:0xf
    s_nop 0
    v_add_f32_dpp v17, v17, v17 row_bcast:31 row_mask:0xc bank_mask:0xf
    v_add_f32_dpp v19, v19, v19 row_bcast:31 row_mask:0xc bank_mask:0xf
    v_mul_f32 v17, 0x3acccccd, v17
    v_mul_f32 v19, 0x3acccccd, v19
    v_fma_f32 v19, -v17, v17, v19
    v_max_f32 v19, 0, v19
    v_cvt_pk_bf16_f32 v128, v17, v17
    v_xor_b32 v128, 0x80008000, v128
    v_cvt_pk_bf16_f32 v19, v19, v19
    v_lshlrev_b32 v19, 16, v19
    v_add_f32 v19, 0x3727c5ac, v19
    v_cvt_pk_bf16_f32 v19, v19, v19
    v_lshlrev_b32 v19, 16, v19
    v_sqrt_f32 v19, v19
    s_nop 0
    v_cvt_pk_bf16_f32 v19, v19, v19
    v_lshlrev_b32 v19, 16, v19
    v_rcp_f32 v129, v19
    v_lshlrev_b32 v23, 3, v23
    v_cmp_eq_u32 vcc, 63, v0
    s_nop 0
    s_and_saveexec_b64 s[78:79], vcc
    buffer_store_dwordx2 v[128:129], v23, s[48:51], s76 offen sc0 sc1
    s_mov_b64 exec, s[78:79]
    s_waitcnt vmcnt(0)
    s_barrier
    s_cmp_eq_u32 s52, 0
    s_cbranch_scc0 K1_RLSG
    v_mov_b32 v135, 0
K1_NC4:
    buffer_load_dword v134, v135, s[72:75], 0 offen sc1
    s_waitcnt vmcnt(0)
    v_readfirstlane_b32 s3, v134
    s_nop 3
    s_cmp_lg_u32 s3, 0
    s_cbranch_scc1 K1_NC4_OK
    s_sleep 2
    s_branch K1_NC4
K1_NC4_OK:
    s_mov_b64 exec, 1
    v_mov_b32 v134, s3
    s_lshl_b32 s63, s2, 2
    s_add_u32 s63, s63, 19880960
    s_nop 1
    buffer_store_dword v134, v135, s[48:51], s63 offen sc0 sc1
    v_mov_b32 v135, 163328
    s_nop 0
    ds_write_b32 v135, v134 offset:4
    s_mov_b64 exec, -1
K1_RLSG:
    v_mov_b32 v17, 0
    v_mov_b32 v18, 0
    v_mov_b32 v19, 0
    v_mov_b32 v20, 0
    s_add_u32 s4, s70, 0
    s_mul_i32 s4, s4, 20480
    s_mul_i32 s5, s53, 5120
    s_add_u32 s4, s4, s5
    s_add_u32 s4, s4, 9081856
    s_add_u32 s5, s4, 4096
    ds_read_b64_tr_b16 v[32:33], v30 offset:0
    ds_read_b64_tr_b16 v[34:35], v30 offset:2560
    ds_read_b64_tr_b16 v[36:37], v30 offset:64
    ds_read_b64_tr_b16 v[38:39], v30 offset:2624
    ds_read_b64_tr_b16 v[40:41], v30 offset:128
    ds_read_b64_tr_b16 v[42:43], v30 offset:2688
    ds_read_b64_tr_b16 v[44:45], v30 offset:192
    ds_read_b64_tr_b16 v[46:47], v30 offset:2752
    ds_read_b64_tr_b16 v[48:49], v30 offset:256
    ds_read_b64_tr_b16 v[50:51], v30 offset:2816
    s_waitcnt lgkmcnt(8)
    buffer_store_dwordx4 v[32:35], v16, s[48:51], s4 offen offset:0 sc0 sc1
    s_waitcnt lgkmcnt(6)
    buffer_store_dwordx4 v[36:39], v16, s[48:51], s4 offen offset:1024 sc0 sc1
    s_waitcnt lgkmcnt(4)
    buffer_store_dwordx4 v[40:43], v16, s[48:51], s4 offen offset:2048 sc0 sc1
    s_waitcnt lgkmcnt(2)
    buffer_store_dwordx4 v[44:47], v16, s[48:51], s4 offen offset:3072 sc0 sc1
    s_waitcnt lgkmcnt(0)
    buffer_store_dwordx4 v[48:51], v16, s[48:51], s5 offen offset:0 sc0 sc1
    s_add_u32 s4, s70, 96
    s_add_u32 s6, s65, 0
    s_cmp_ge_u32 s4, 96
    s_cbranch_scc1 K1_RI_WO3
    s_mov_b32 s40, s32
    s_mov_b32 s41, s33
    s_mov_b32 s42, 1966080
    s_mov_b32 s43, 0x00020000
    s_mul_i32 s5, s4, 20480
    s_branch K1_RI_REG3
K1_RI_WO3:
    s_mov_b32 s40, s24
    s_mov_b32 s41, s25
    s_mov_b32 s42, 819200
    s_mov_b32 s43, 0x00020000
    s_sub_u32 s4, s4, 96
    s_mul_i32 s5, s4, 25600
    s_cmp_lt_u32 s4, 32
    s_cbranch_scc1 K1_RI_REG3
    s_sub_u32 s4, s4, 32
    s_lshr_b32 s5, s4, 1
    s_lshl_b32 s5, s5, 3
    s_and_b32 s4, s4, 1
    s_lshl_b32 s4, s4, 1
    s_add_u32 s5, s5, s4
    s_mul_i32 s5, s5, 20
    s_add_u32 s5, s5, 16
    s_mul_i32 s5, s5, 1280
    s_add_u32 m0, s6, 0
    s_nop 0
    buffer_load_dwordx4 v65, s[40:43], s5 offen  lds
    s_add_u32 m0, s6, 1024
    s_nop 0
    buffer_load_dwordx4 v66, s[40:43], s5 offen  lds
    s_add_u32 m0, s6, 2048
    s_nop 0
    buffer_load_dwordx4 v67, s[40:43], s5 offen  lds
    s_add_u32 m0, s6, 3072
    s_nop 0
    buffer_load_dwordx4 v68, s[40:43], s5 offen  lds
    s_add_u32 m0, s6, 4096
    s_nop 0
    buffer_load_dwordx4 v69, s[40:43], s5 offen  lds
    s_branch K1_RI_DONE3
K1_RI_REG3:
    s_add_u32 m0, s6, 0
    s_nop 0
    buffer_load_dwordx4 v60, s[40:43], s5 offen  lds
    s_add_u32 m0, s6, 1024
    s_nop 0
    buffer_load_dwordx4 v61, s[40:43], s5 offen  lds
    s_add_u32 m0, s6, 2048
    s_nop 0
    buffer_load_dwordx4 v62, s[40:43], s5 offen  lds
    s_add_u32 m0, s6, 3072
    s_nop 0
    buffer_load_dwordx4 v63, s[40:43], s5 offen  lds
    s_add_u32 m0, s6, 4096
    s_nop 0
    buffer_load_dwordx4 v64, s[40:43], s5 offen  lds
K1_RI_DONE3:
    s_add_u32 s4, s70, 32
    s_mul_i32 s4, s4, 20480
    s_mul_i32 s5, s53, 5120
    s_add_u32 s4, s4, s5
    s_add_u32 s4, s4, 9081856
    s_add_u32 s5, s4, 4096
    ds_read_b64_tr_b16 v[32:33], v30 offset:5120
    ds_read_b64_tr_b16 v[34:35], v30 offset:7680
    ds_read_b64_tr_b16 v[36:37], v30 offset:5184
    ds_read_b64_tr_b16 v[38:39], v30 offset:7744
    ds_read_b64_tr_b16 v[40:41], v30 offset:5248
    ds_read_b64_tr_b16 v[42:43], v30 offset:7808
    ds_read_b64_tr_b16 v[44:45], v30 offset:5312
    ds_read_b64_tr_b16 v[46:47], v30 offset:7872
    ds_read_b64_tr_b16 v[48:49], v30 offset:5376
    ds_read_b64_tr_b16 v[50:51], v30 offset:7936
    s_waitcnt lgkmcnt(8)
    buffer_store_dwordx4 v[32:35], v16, s[48:51], s4 offen offset:0 sc0 sc1
    s_waitcnt lgkmcnt(6)
    buffer_store_dwordx4 v[36:39], v16, s[48:51], s4 offen offset:1024 sc0 sc1
    s_waitcnt lgkmcnt(4)
    buffer_store_dwordx4 v[40:43], v16, s[48:51], s4 offen offset:2048 sc0 sc1
    s_waitcnt lgkmcnt(2)
    buffer_store_dwordx4 v[44:47], v16, s[48:51], s4 offen offset:3072 sc0 sc1
    s_waitcnt lgkmcnt(0)
    buffer_store_dwordx4 v[48:51], v16, s[48:51], s5 offen offset:0 sc0 sc1
    s_cmp_ge_u32 s70, 8
    s_cbranch_scc1 K1_RI_NO5
    s_add_u32 s4, s70, 128
    s_add_u32 s6, s65, 5120
    s_cmp_ge_u32 s4, 96
    s_cbranch_scc1 K1_RI_WO4
    s_mov_b32 s40, s32
    s_mov_b32 s41, s33
    s_mov_b32 s42, 1966080
    s_mov_b32 s43, 0x00020000
    s_mul_i32 s5, s4, 20480
    s_branch K1_RI_REG4
K1_RI_WO4:
    s_mov_b32 s40, s24
    s_mov_b32 s41, s25
    s_mov_b32 s42, 819200
    s_mov_b32 s43, 0x00020000
    s_sub_u32 s4, s4, 96
    s_mul_i32 s5, s4, 25600
    s_cmp_lt_u32 s4, 32
    s_cbranch_scc1 K1_RI_REG4
    s_sub_u32 s4, s4, 32
    s_lshr_b32 s5, s4, 1
    s_lshl_b32 s5, s5, 3
    s_and_b32 s4, s4, 1
    s_lshl_b32 s4, s4, 1
    s_add_u32 s5, s5, s4
    s_mul_i32 s5, s5, 20
    s_add_u32 s5, s5, 16
    s_mul_i32 s5, s5, 1280
    s_add_u32 m0, s6, 0
    s_nop 0
    buffer_load_dwordx4 v65, s[40:43], s5 offen  lds
    s_add_u32 m0, s6, 1024
    s_nop 0
    buffer_load_dwordx4 v66, s[40:43], s5 offen  lds
    s_add_u32 m0, s6, 2048
    s_nop 0
    buffer_load_dwordx4 v67, s[40:43], s5 offen  lds
    s_add_u32 m0, s6, 3072
    s_nop 0
    buffer_load_dwordx4 v68, s[40:43], s5 offen  lds
    s_add_u32 m0, s6, 4096
    s_nop 0
    buffer_load_dwordx4 v69, s[40:43], s5 offen  lds
    s_branch K1_RI_DONE4
K1_RI_REG4:
    s_add_u32 m0, s6, 0
    s_nop 0
    buffer_load_dwordx4 v60, s[40:43], s5 offen  lds
    s_add_u32 m0, s6, 1024
    s_nop 0
    buffer_load_dwordx4 v61, s[40:43], s5 offen  lds
    s_add_u32 m0, s6, 2048
    s_nop 0
    buffer_load_dwordx4 v62, s[40:43], s5 offen  lds
    s_add_u32 m0, s6, 3072
    s_nop 0
    buffer_load_dwordx4 v63, s[40:43], s5 offen  lds
    s_add_u32 m0, s6, 4096
    s_nop 0
    buffer_load_dwordx4 v64, s[40:43], s5 offen  lds
K1_RI_DONE4:
K1_RI_NO5:
    s_add_u32 s4, s70, 64
    s_mul_i32 s4, s4, 20480
    s_mul_i32 s5, s53, 5120
    s_add_u32 s4, s4, s5
    s_add_u32 s4, s4, 9081856
    s_add_u32 s5, s4, 4096
    ds_read_b64_tr_b16 v[32:33], v30 offset:10240
    ds_read_b64_tr_b16 v[34:35], v30 offset:12800
    ds_read_b64_tr_b16 v[36:37], v30 offset:10304
    ds_read_b64_tr_b16 v[38:39], v30 offset:12864
    ds_read_b64_tr_b16 v[40:41], v30 offset:10368
    ds_read_b64_tr_b16 v[42:43], v30 offset:12928
    ds_read_b64_tr_b16 v[44:45], v30 offset:10432
    ds_read_b64_tr_b16 v[46:47], v30 offset:12992
    ds_read_b64_tr_b16 v[48:49], v30 offset:10496
    ds_read_b64_tr_b16 v[50:51], v30 offset:13056
    s_waitcnt lgkmcnt(8)
    buffer_store_dwordx4 v[32:35], v16, s[48:51], s4 offen offset:0 sc0 sc1
    s_waitcnt lgkmcnt(6)
    buffer_store_dwordx4 v[36:39], v16, s[48:51], s4 offen offset:1024 sc0 sc1
    s_waitcnt lgkmcnt(4)
    buffer_store_dwordx4 v[40:43], v16, s[48:51], s4 offen offset:2048 sc0 sc1
    s_waitcnt lgkmcnt(2)
    buffer_store_dwordx4 v[44:47], v16, s[48:51], s4 offen offset:3072 sc0 sc1
    s_waitcnt lgkmcnt(0)
    buffer_store_dwordx4 v[48:51], v16, s[48:51], s5 offen offset:0 sc0 sc1
    s_waitcnt vmcnt(0)
    s_add_u32 s4, s70, 96
    s_mul_i32 s4, s4, 20480
    s_mul_i32 s5, s53, 5120
    s_add_u32 s4, s4, s5
    s_add_u32 s4, s4, 9081856
    s_add_u32 s5, s4, 4096
    ds_read_b64_tr_b16 v[32:33], v30 offset:0
    ds_read_b64_tr_b16 v[34:35], v30 offset:2560
    ds_read_b64_tr_b16 v[36:37], v30 offset:64
    ds_read_b64_tr_b16 v[38:39], v30 offset:2624
    ds_read_b64_tr_b16 v[40:41], v30 offset:128
    ds_read_b64_tr_b16 v[42:43], v30 offset:2688
    ds_read_b64_tr_b16 v[44:45], v30 offset:192
    ds_read_b64_tr_b16 v[46:47], v30 offset:2752
    ds_read_b64_tr_b16 v[48:49], v30 offset:256
    ds_read_b64_tr_b16 v[50:51], v30 offset:2816
    s_waitcnt lgkmcnt(8)
    buffer_store_dwordx4 v[32:35], v16, s[48:51], s4 offen offset:0 sc0 sc1
    s_waitcnt lgkmcnt(6)
    buffer_store_dwordx4 v[36:39], v16, s[48:51], s4 offen offset:1024 sc0 sc1
    s_waitcnt lgkmcnt(4)
    buffer_store_dwordx4 v[40:43], v16, s[48:51], s4 offen offset:2048 sc0 sc1
    s_waitcnt lgkmcnt(2)
    buffer_store_dwordx4 v[44:47], v16, s[48:51], s4 offen offset:3072 sc0 sc1
    s_waitcnt lgkmcnt(0)
    buffer_store_dwordx4 v[48:51], v16, s[48:51], s5 offen offset:0 sc0 sc1
    s_cmp_ge_u32 s70, 8
    s_cbranch_scc1 K1_ENDL
    s_add_u32 s4, s70, 128
    s_mul_i32 s4, s4, 20480
    s_mul_i32 s5, s53, 5120
    s_add_u32 s4, s4, s5
    s_add_u32 s4, s4, 9081856
    s_add_u32 s5, s4, 4096
    ds_read_b64_tr_b16 v[32:33], v30 offset:5120
    ds_read_b64_tr_b16 v[34:35], v30 offset:7680
    ds_read_b64_tr_b16 v[36:37], v30 offset:5184
    ds_read_b64_tr_b16 v[38:39], v30 offset:7744
    ds_read_b64_tr_b16 v[40:41], v30 offset:5248
    ds_read_b64_tr_b16 v[42:43], v30 offset:7808
    ds_read_b64_tr_b16 v[44:45], v30 offset:5312
    ds_read_b64_tr_b16 v[46:47], v30 offset:7872
    ds_read_b64_tr_b16 v[48:49], v30 offset:5376
    ds_read_b64_tr_b16 v[50:51], v30 offset:7936
    s_waitcnt lgkmcnt(8)
    buffer_store_dwordx4 v[32:35], v16, s[48:51], s4 offen offset:0 sc0 sc1
    s_waitcnt lgkmcnt(6)
    buffer_store_dwordx4 v[36:39], v16, s[48:51], s4 offen offset:1024 sc0 sc1
    s_waitcnt lgkmcnt(4)
    buffer_store_dwordx4 v[40:43], v16, s[48:51], s4 offen offset:2048 sc0 sc1
    s_waitcnt lgkmcnt(2)
    buffer_store_dwordx4 v[44:47], v16, s[48:51], s4 offen offset:3072 sc0 sc1
    s_waitcnt lgkmcnt(0)
    buffer_store_dwordx4 v[48:51], v16, s[48:51], s5 offen offset:0 sc0 sc1
K1_ENDL:
    s_waitcnt lgkmcnt(0)
    s_barrier
K1_END:
    s_and_b32 s63, s2, 7
    s_lshl_b32 s63, s63, 7
    s_add_u32 s63, s63, 96
    v_lshlrev_b32 v165, 2, v0
    v_add_u32 v166, s63, v165
    v_add_u32 v165, 1004, v165
    v_cmp_gt_u32 vcc, 5, v0
    s_nop 1
    v_cndmask_b32 v165, v165, v166, vcc
    v_mov_b32 v166, 1024
    v_cmp_gt_u32 vcc, 13, v0
    s_nop 1
    v_cndmask_b32 v165, v166, v165, vcc
    s_mov_b32 s27, 19878912
    s_cmp_lg_u32 s52, 0
    s_cbranch_scc1 PA_NP
    buffer_load_dword v164, v165, s[48:51], s27 offen sc1
PA_NP:
    s_load_dwordx2 s[16:17], s[0:1], 0
    s_load_dwordx2 s[18:19], s[0:1], 72
    s_and_b32 s63, s2, 7
    s_lshr_b32 s67, s2, 3
    s_lshl_b32 s55, s63, 3
    s_lshr_b32 s68, s67, 2
    s_add_u32 s55, s55, s68
    s_and_b32 s56, s67, 3
    s_nop 4
    v_lshlrev_b32 v1, 4, v0
    v_and_b32 v126, 7, v0
    s_lshl_b32 s63, s56, 3
    v_add_u32 v126, s63, v126
    v_bfe_u32 v127, v0, 3, 2
    v_lshrrev_b32 v128, 5, v0
    s_lshl_b32 s63, s52, 2
    v_add_u32 v129, s63, v127
    v_mul_u32_u24 v129, 5, v129
    s_mul_i32 s61, s55, 40960
    v_and_b32 v124, 31, v0
    v_lshlrev_b32 v2, 3, v124
    v_add_u32 v2, 1024, v2
    v_cmp_gt_u32 vcc, 32, v0
    v_mov_b32 v132, 1936
    s_nop 0
    v_cndmask_b32 v2, v132, v2, vcc
    v_mul_u32_u24 v3, 336, v128
    v_lshl_add_u32 v3, v124, 4, v3
    v_add_u32 v3, 1280, v3
    v_cmp_gt_u32 vcc, 20, v124
    s_nop 1
    v_cndmask_b32 v3, v132, v3, vcc
    v_and_b32 v133, 27, v124
    v_cmp_eq_u32 vcc, 24, v133
    v_mov_b32 v132, 1600
    s_nop 0
    v_cndmask_b32 v3, v3, v132, vcc
    v_add_u32 v132, v129, v128
    v_lshrrev_b32 v130, 2, v132
    v_lshlrev_b32 v130, 10, v130
    v_and_b32 v131, 1, v132
    v_lshl_add_u32 v131, v131, 5, v126
    v_lshl_add_u32 v130, v131, 4, v130
    v_bfe_u32 v131, v132, 1, 1
    v_lshl_add_u32 v133, v131, 3, v130
    v_add_u32 v132, 2, v132
    v_lshrrev_b32 v130, 2, v132
    v_lshlrev_b32 v130, 10, v130
    v_and_b32 v131, 1, v132
    v_lshl_add_u32 v131, v131, 5, v126
    v_lshl_add_u32 v130, v131, 4, v130
    v_bfe_u32 v131, v132, 1, 1
    v_lshl_add_u32 v134, v131, 3, v130
    v_add_u32 v132, 4, v129
    v_lshrrev_b32 v130, 2, v132
    v_lshlrev_b32 v130, 10, v130
    v_and_b32 v131, 1, v132
    v_lshl_add_u32 v131, v131, 5, v126
    v_lshl_add_u32 v130, v131, 4, v130
    v_bfe_u32 v131, v132, 1, 1
    v_lshl_add_u32 v135, v131, 3, v130
    v_lshlrev_b32 v124, 2, v0
    s_mov_b32 s60, 9080832
    s_mov_b32 s64, 8912896
    s_add_u32 s65, s64, 2624
    v_mov_b32 v36, 0
    v_mov_b32 v37, 0
    v_mov_b32 v38, 0
    v_mov_b32 v39, 0
    v_mov_b32 v40, 0
    v_mov_b32 v41, 0
    v_mov_b32 v42, 0
    v_mov_b32 v43, 0
    v_mov_b32 v52, 0
    v_mov_b32 v53, 0
    v_mov_b32 v54, 0
    v_mov_b32 v55, 0
    v_mov_b32 v56, 0
    v_mov_b32 v57, 0
    v_mov_b32 v58, 0
    v_mov_b32 v59, 0
    v_mov_b32 v92, 0
    v_mov_b32 v93, 0
    v_mov_b32 v94, 0
    v_mov_b32 v95, 0
    v_mov_b32 v96, 0
    v_mov_b32 v97, 0
    v_mov_b32 v98, 0
    v_mov_b32 v99, 0
    v_mov_b32 v100, 0
    v_mov_b32 v101, 0
    v_mov_b32 v102, 0
    v_mov_b32 v103, 0
    v_mov_b32 v104, 0
    v_mov_b32 v105, 0
    v_mov_b32 v106, 0
    v_mov_b32 v107, 0
    s_waitcnt vmcnt(0) lgkmcnt(0)
    s_mov_b64 exec, 1
    v_mov_b32 v166, 163328
    v_mov_b32 v167, 1
    s_nop 0
    ds_add_rtn_u32 v167, v166, v167
    ds_read_b32 v166, v166 offset:4
    s_waitcnt lgkmcnt(0)
    v_readfirstlane_b32 s63, v167
    v_mov_b32 v167, 0
    s_nop 3
    s_cmp_lg_u32 s63, 7
    s_cbranch_scc1 PA_NOFLAG
    buffer_store_dword v166, v167, s[48:51], s26 offen sc0 sc1
PA_NOFLAG:
    s_mov_b64 exec, -1
    s_cmp_lg_u32 s52, 0
    s_cbranch_scc1 PA_OK1
PA_POLL1:
    v_cmp_eq_u32 vcc, s3, v164
    s_nop 3
    s_or_b32 vcc_lo, vcc_lo, 31
    s_cmp_eq_u64 vcc, exec
    s_cbranch_scc1 PA_OK1
    s_sleep 1
    buffer_load_dword v164, v165, s[48:51], s27 offen sc1
    s_waitcnt vmcnt(0)
    s_branch PA_POLL1
PA_OK1:
    s_barrier
    s_setprio 2
    buffer_load_dword v125, v124, s[48:51], s60 offen sc1
    buffer_load_dwordx4 v[12:15], v1, s[48:51], s64 offen offset:0 sc1
    buffer_load_dwordx2 v[16:17], v2, s[48:51], s64 offen offset:0 sc1
    buffer_load_dwordx4 v[20:23], v1, s[48:51], s64 offen offset:2624 sc1
    buffer_load_dwordx2 v[24:25], v2, s[48:51], s64 offen offset:2624 sc1
    s_lshl_b32 s62, s52, 10
    s_add_u32 s63, s62, 8918144
    buffer_load_dwordx4 v[28:31], v3, s[48:51], s64 offen offset:0 sc1
    buffer_load_dwordx4 v[32:35], v3, s[48:51], s64 offen offset:672 sc1
    buffer_load_dwordx4 v[36:39], v3, s[48:51], s65 offen offset:0 sc1
    buffer_load_dwordx4 v[40:43], v3, s[48:51], s65 offen offset:672 sc1
    s_cmp_lg_u32 s52, 0
    s_cbranch_scc1 PA_OK2
PA_POLL2:
    v_cmp_eq_u32 vcc, s3, v164
    s_nop 3
    s_cmp_eq_u64 vcc, exec
    s_cbranch_scc1 PA_OK2
    buffer_load_dword v164, v165, s[48:51], s27 offen sc1
    s_waitcnt vmcnt(0)
    s_branch PA_POLL2
PA_OK2:
    s_barrier
    buffer_load_dwordx2 v[4:5], v133, s[48:51], s61 offen sc1
    buffer_load_dwordx2 v[6:7], v134, s[48:51], s61 offen sc1
    buffer_load_dwordx2 v[8:9], v135, s[48:51], s61 offen sc1
    s_waitcnt vmcnt(11)
    v_max_f32_dpp v125, v125, v125 row_ror:8 row_mask:0xf bank_mask:0xf
    s_nop 1
    v_max_f32_dpp v125, v125, v125 row_ror:4 row_mask:0xf bank_mask:0xf
    s_nop 1
    v_max_f32_dpp v125, v125, v125 row_ror:2 row_mask:0xf bank_mask:0xf
    s_nop 1
    v_max_f32_dpp v125, v125, v125 row_ror:1 row_mask:0xf bank_mask:0xf
    v_mov_b32 v132, v125
    s_nop 1
    v_permlane16_swap_b32 v125, v132
    v_max_f32 v125, v125, v132
    v_mov_b32 v132, v125
    s_nop 1
    v_permlane32_swap_b32 v125, v132
    v_max_f32 v125, v125, v132
    s_waitcnt vmcnt(0)
    v_cmp_gt_u32 vcc, 32, v0
    s_nop 1
    v_cndmask_b32 v8, 0, v8, vcc
    v_cndmask_b32 v9, 0, v9, vcc
    v_mov_b32 v10, 0
    v_mov_b32 v11, 0
    v_mov_b32 v130, 0
    v_dot2_f32_bf16 v130, v4, v4, v130
    v_dot2_f32_bf16 v130, v5, v5, v130
    v_dot2_f32_bf16 v130, v6, v6, v130
    v_dot2_f32_bf16 v130, v7, v7, v130
    v_dot2_f32_bf16 v130, v8, v8, v130
    v_dot2_f32_bf16 v130, v9, v9, v130
    s_nop 2
    v_mov_b32 v131, v130
    s_nop 1
    v_permlane32_swap_b32 v130, v131
    v_add_f32 v130, v130, v131
    v_mul_f32 v130, v130, v125
    v_sqrt_f32 v130, v130
    s_nop 0
    v_mul_f32 v130, 0x3f8147ae, v130
    v_cmp_ge_f32 vcc, 0x42400000, v130
    s_mov_b32 s74, 1
    s_cmp_eq_u64 vcc, exec
    s_cbranch_scc1 K2_FAST
    s_waitcnt vmcnt(0)
    s_barrier
    s_barrier
    s_barrier
    s_mov_b32 s74, 0
    v_mov_b32 v130, 0xff800000
    v_mfma_f32_32x32x16_bf16 v[60:75], v[12:15], v[4:7], 0
    s_nop 9
    v_mfma_f32_32x32x8_bf16 v[60:75], v[16:17], v[8:9], v[60:75]
    s_nop 11
    v_max3_f32 v130, v60, v61, v130
    v_max3_f32 v130, v62, v63, v130
    v_max3_f32 v130, v64, v65, v130
    v_max3_f32 v130, v66, v67, v130
    v_max3_f32 v130, v68, v69, v130
    v_max3_f32 v130, v70, v71, v130
    v_max3_f32 v130, v72, v73, v130
    v_max3_f32 v130, v74, v75, v130
    v_mfma_f32_32x32x16_bf16 v[60:75], v[20:23], v[4:7], 0
    s_nop 9
    v_mfma_f32_32x32x8_bf16 v[60:75], v[24:25], v[8:9], v[60:75]
    s_nop 11
    v_max3_f32 v130, v60, v61, v130
    v_max3_f32 v130, v62, v63, v130
    v_max3_f32 v130, v64, v65, v130
    v_max3_f32 v130, v66, v67, v130
    v_max3_f32 v130, v68, v69, v130
    v_max3_f32 v130, v70, v71, v130
    v_max3_f32 v130, v72, v73, v130
    v_max3_f32 v130, v74, v75, v130
    v_mov_b32 v134, v1
    v_mov_b32 v135, v2
    s_mov_b32 s73, 62
    v_mov_b32 v82, 0
    v_mov_b32 v83, 0
    s_nop 1
K2_PRE:
    ds_read_b128 v[76:79], v134
    ds_read_b64 v[80:81], v135
    v_add_u32 v134, 2624, v134
    v_add_u32 v135, 2624, v135
    s_waitcnt lgkmcnt(0)
    v_mfma_f32_32x32x16_bf16 v[60:75], v[76:79], v[4:7], 0
    s_nop 9
    v_mfma_f32_32x32x8_bf16 v[60:75], v[80:81], v[8:9], v[60:75]
    s_nop 11
    v_max3_f32 v130, v60, v61, v130
    v_max3_f32 v130, v62, v63, v130
    v_max3_f32 v130, v64, v65, v130
    v_max3_f32 v130, v66, v67, v130
    v_max3_f32 v130, v68, v69, v130
    v_max3_f32 v130, v70, v71, v130
    v_max3_f32 v130, v72, v73, v130
    v_max3_f32 v130, v74, v75, v130
    s_sub_u32 s73, s73, 1
    s_cmp_lg_u32 s73, 0
    s_cbranch_scc1 K2_PRE
    v_mov_b32 v131, v130
    s_nop 1
    v_permlane32_swap_b32 v130, v131
    v_max_f32 v130, v130, v131
    s_nop 1
K2_FAST:
    v_sub_f32 v108, 0, v130
    v_sub_f32 v109, 0, v130
    v_sub_f32 v110, 0, v130
    v_sub_f32 v111, 0, v130
    v_sub_f32 v112, 0, v130
    v_sub_f32 v113, 0, v130
    v_sub_f32 v114, 0, v130
    v_sub_f32 v115, 0, v130
    v_sub_f32 v116, 0, v130
    v_sub_f32 v117, 0, v130
    v_sub_f32 v118, 0, v130
    v_sub_f32 v119, 0, v130
    v_sub_f32 v120, 0, v130
    v_sub_f32 v121, 0, v130
    v_sub_f32 v122, 0, v130
    v_sub_f32 v123, 0, v130
    s_nop 1
    v_mfma_f32_32x32x16_bf16 v[60:75], v[12:15], v[4:7], v[108:123]
    s_nop 9
    v_mfma_f32_32x32x8_bf16 v[60:75], v[16:17], v[8:9], v[60:75]
    s_waitcnt lgkmcnt(0)
    v_mfma_f32_32x32x16_bf16 v[76:91], v[20:23], v[4:7], v[108:123]
    s_nop 9
    v_exp_f32 v60, v60
    v_exp_f32 v61, v61
    v_exp_f32 v62, v62
    v_exp_f32 v63, v63
    v_mfma_f32_32x32x16_bf16 v[92:107], v[36:39], v[52:55], v[92:107]
    v_exp_f32 v64, v64
    v_cvt_pk_bf16_f32 v44, v60, v61
    v_exp_f32 v65, v65
    v_cvt_pk_bf16_f32 v45, v62, v63
    v_exp_f32 v66, v66
    v_exp_f32 v67, v67
    v_mfma_f32_32x32x8_bf16 v[76:91], v[24:25], v[8:9], v[76:91]
    v_exp_f32 v68, v68
    v_cvt_pk_bf16_f32 v46, v64, v65
    v_exp_f32 v69, v69
    v_cvt_pk_bf16_f32 v47, v66, v67
    v_exp_f32 v70, v70
    v_exp_f32 v71, v71
    v_mfma_f32_32x32x16_bf16 v[92:107], v[40:43], v[56:59], v[92:107]
    v_exp_f32 v72, v72
    v_cvt_pk_bf16_f32 v48, v68, v69
    v_exp_f32 v73, v73
    v_cvt_pk_bf16_f32 v49, v70, v71
    v_exp_f32 v74, v74
    v_exp_f32 v75, v75
    v_cvt_pk_bf16_f32 v50, v72, v73
    v_cvt_pk_bf16_f32 v51, v74, v75
    s_cmp_eq_u32 s74, 1
    s_cbranch_scc0 K2_NOB1
    s_barrier
K2_NOB1:
    ds_read_b128 v[12:15], v1 offset:0
    ds_read_b64 v[16:17], v2 offset:0
    s_waitcnt lgkmcnt(0)
    ds_read_b128 v[20:23], v1 offset:2624
    ds_read_b64 v[24:25], v2 offset:2624
    v_mfma_f32_32x32x16_bf16 v[60:75], v[12:15], v[4:7], v[108:123]
    v_exp_f32 v76, v76
    v_exp_f32 v77, v77
    v_exp_f32 v78, v78
    v_exp_f32 v79, v79
    v_mfma_f32_32x32x16_bf16 v[92:107], v[28:31], v[44:47], v[92:107]
    v_exp_f32 v80, v80
    v_cvt_pk_bf16_f32 v52, v76, v77
    v_exp_f32 v81, v81
    v_cvt_pk_bf16_f32 v53, v78, v79
    v_exp_f32 v82, v82
    v_exp_f32 v83, v83
    v_mfma_f32_32x32x8_bf16 v[60:75], v[16:17], v[8:9], v[60:75]
    v_exp_f32 v84, v84
    v_cvt_pk_bf16_f32 v54, v80, v81
    v_exp_f32 v85, v85
    v_cvt_pk_bf16_f32 v55, v82, v83
    v_exp_f32 v86, v86
    v_exp_f32 v87, v87
    v_mfma_f32_32x32x16_bf16 v[92:107], v[32:35], v[48:51], v[92:107]
    v_exp_f32 v88, v88
    v_cvt_pk_bf16_f32 v56, v84, v85
    v_exp_f32 v89, v89
    v_cvt_pk_bf16_f32 v57, v86, v87
    v_exp_f32 v90, v90
    v_exp_f32 v91, v91
    v_cvt_pk_bf16_f32 v58, v88, v89
    v_cvt_pk_bf16_f32 v59, v90, v91
    s_waitcnt lgkmcnt(0)
    ds_read_b128 v[12:15], v1 offset:5248
    ds_read_b64 v[16:17], v2 offset:5248
    ds_read_b128 v[28:31], v3 offset:0
    ds_read_b128 v[32:35], v3 offset:672
    v_mfma_f32_32x32x16_bf16 v[76:91], v[20:23], v[4:7], v[108:123]
    v_exp_f32 v60, v60
    v_exp_f32 v61, v61
    v_exp_f32 v62, v62
    v_exp_f32 v63, v63
    v_mfma_f32_32x32x16_bf16 v[92:107], v[36:39], v[52:55], v[92:107]
    v_exp_f32 v64, v64
    v_cvt_pk_bf16_f32 v44, v60, v61
    v_exp_f32 v65, v65
    v_cvt_pk_bf16_f32 v45, v62, v63
    v_exp_f32 v66, v66
    v_exp_f32 v67, v67
    v_mfma_f32_32x32x8_bf16 v[76:91], v[24:25], v[8:9], v[76:91]
    v_exp_f32 v68, v68
    v_cvt_pk_bf16_f32 v46, v64, v65
    v_exp_f32 v69, v69
    v_cvt_pk_bf16_f32 v47, v66, v67
    v_exp_f32 v70, v70
    v_exp_f32 v71, v71
    v_mfma_f32_32x32x16_bf16 v[92:107], v[40:43], v[56:59], v[92:107]
    v_exp_f32 v72, v72
    v_cvt_pk_bf16_f32 v48, v68, v69
    v_exp_f32 v73, v73
    v_cvt_pk_bf16_f32 v49, v70, v71
    v_exp_f32 v74, v74
    v_exp_f32 v75, v75
    v_cvt_pk_bf16_f32 v50, v72, v73
    v_cvt_pk_bf16_f32 v51, v74, v75
    s_waitcnt lgkmcnt(0)
    ds_read_b128 v[20:23], v1 offset:7872
    ds_read_b64 v[24:25], v2 offset:7872
    ds_read_b128 v[36:39], v3 offset:2624
    ds_read_b128 v[40:43], v3 offset:3296
    v_mfma_f32_32x32x16_bf16 v[60:75], v[12:15], v[4:7], v[108:123]
    v_exp_f32 v76, v76
    v_exp_f32 v77, v77
    v_exp_f32 v78, v78
    v_exp_f32 v79, v79
    v_mfma_f32_32x32x16_bf16 v[92:107], v[28:31], v[44:47], v[92:107]
    v_exp_f32 v80, v80
    v_cvt_pk_bf16_f32 v52, v76, v77
    v_exp_f32 v81, v81
    v_cvt_pk_bf16_f32 v53, v78, v79
    v_exp_f32 v82, v82
    v_exp_f32 v83, v83
    v_mfma_f32_32x32x8_bf16 v[60:75], v[16:17], v[8:9], v[60:75]
    v_exp_f32 v84, v84
    v_cvt_pk_bf16_f32 v54, v80, v81
    v_exp_f32 v85, v85
    v_cvt_pk_bf16_f32 v55, v82, v83
    v_exp_f32 v86, v86
    v_exp_f32 v87, v87
    v_mfma_f32_32x32x16_bf16 v[92:107], v[32:35], v[48:51], v[92:107]
    v_exp_f32 v88, v88
    v_cvt_pk_bf16_f32 v56, v84, v85
    v_exp_f32 v89, v89
    v_cvt_pk_bf16_f32 v57, v86, v87
    v_exp_f32 v90, v90
    v_exp_f32 v91, v91
    v_cvt_pk_bf16_f32 v58, v88, v89
    v_cvt_pk_bf16_f32 v59, v90, v91
    s_waitcnt lgkmcnt(0)
    ds_read_b128 v[12:15], v1 offset:10496
    ds_read_b64 v[16:17], v2 offset:10496
    ds_read_b128 v[28:31], v3 offset:5248
    ds_read_b128 v[32:35], v3 offset:5920
    v_mfma_f32_32x32x16_bf16 v[76:91], v[20:23], v[4:7], v[108:123]
    v_exp_f32 v60, v60
    v_exp_f32 v61, v61
    v_exp_f32 v62, v62
    v_exp_f32 v63, v63
    v_mfma_f32_32x32x16_bf16 v[92:107], v[36:39], v[52:55], v[92:107]
    v_exp_f32 v64, v64
    v_cvt_pk_bf16_f32 v44, v60, v61
    v_exp_f32 v65, v65
    v_cvt_pk_bf16_f32 v45, v62, v63
    v_exp_f32 v66, v66
    v_exp_f32 v67, v67
    v_mfma_f32_32x32x8_bf16 v[76:91], v[24:25], v[8:9], v[76:91]
    v_exp_f32 v68, v68
    v_cvt_pk_bf16_f32 v46, v64, v65
    v_exp_f32 v69, v69
    v_cvt_pk_bf16_f32 v47, v66, v67
    v_exp_f32 v70, v70
    v_exp_f32 v71, v71
    v_mfma_f32_32x32x16_bf16 v[92:107], v[40:43], v[56:59], v[92:107]
    v_exp_f32 v72, v72
    v_cvt_pk_bf16_f32 v48, v68, v69
    v_exp_f32 v73, v73
    v_cvt_pk_bf16_f32 v49, v70, v71
    v_exp_f32 v74, v74
    v_exp_f32 v75, v75
    v_cvt_pk_bf16_f32 v50, v72, v73
    v_cvt_pk_bf16_f32 v51, v74, v75
    s_waitcnt lgkmcnt(0)
    ds_read_b128 v[20:23], v1 offset:13120
    ds_read_b64 v[24:25], v2 offset:13120
    ds_read_b128 v[36:39], v3 offset:7872
    ds_read_b128 v[40:43], v3 offset:8544
    v_mfma_f32_32x32x16_bf16 v[60:75], v[12:15], v[4:7], v[108:123]
    v_exp_f32 v76, v76
    v_exp_f32 v77, v77
    v_exp_f32 v78, v78
    v_exp_f32 v79, v79
    v_mfma_f32_32x32x16_bf16 v[92:107], v[28:31], v[44:47], v[92:107]
    v_exp_f32 v80, v80
    v_cvt_pk_bf16_f32 v52, v76, v77
    v_exp_f32 v81, v81
    v_cvt_pk_bf16_f32 v53, v78, v79
    v_exp_f32 v82, v82
    v_exp_f32 v83, v83
    v_mfma_f32_32x32x8_bf16 v[60:75], v[16:17], v[8:9], v[60:75]
    v_exp_f32 v84, v84
    v_cvt_pk_bf16_f32 v54, v80, v81
    v_exp_f32 v85, v85
    v_cvt_pk_bf16_f32 v55, v82, v83
    v_exp_f32 v86, v86
    v_exp_f32 v87, v87
    v_mfma_f32_32x32x16_bf16 v[92:107], v[32:35], v[48:51], v[92:107]
    v_exp_f32 v88, v88
    v_cvt_pk_bf16_f32 v56, v84, v85
    v_exp_f32 v89, v89
    v_cvt_pk_bf16_f32 v57, v86, v87
    v_exp_f32 v90, v90
    v_exp_f32 v91, v91
    v_cvt_pk_bf16_f32 v58, v88, v89
    v_cvt_pk_bf16_f32 v59, v90, v91
    s_waitcnt lgkmcnt(0)
    ds_read_b128 v[12:15], v1 offset:15744
    ds_read_b64 v[16:17], v2 offset:15744
    ds_read_b128 v[28:31], v3 offset:10496
    ds_read_b128 v[32:35], v3 offset:11168
    v_mfma_f32_32x32x16_bf16 v[76:91], v[20:23], v[4:7], v[108:123]
    v_exp_f32 v60, v60
    v_exp_f32 v61, v61
    v_exp_f32 v62, v62
    v_exp_f32 v63, v63
    v_mfma_f32_32x32x16_bf16 v[92:107], v[36:39], v[52:55], v[92:107]
    v_exp_f32 v64, v64
    v_cvt_pk_bf16_f32 v44, v60, v61
    v_exp_f32 v65, v65
    v_cvt_pk_bf16_f32 v45, v62, v63
    v_exp_f32 v66, v66
    v_exp_f32 v67, v67
    v_mfma_f32_32x32x8_bf16 v[76:91], v[24:25], v[8:9], v[76:91]
    v_exp_f32 v68, v68
    v_cvt_pk_bf16_f32 v46, v64, v65
    v_exp_f32 v69, v69
    v_cvt_pk_bf16_f32 v47, v66, v67
    v_exp_f32 v70, v70
    v_exp_f32 v71, v71
    v_mfma_f32_32x32x16_bf16 v[92:107], v[40:43], v[56:59], v[92:107]
    v_exp_f32 v72, v72
    v_cvt_pk_bf16_f32 v48, v68, v69
    v_exp_f32 v73, v73
    v_cvt_pk_bf16_f32 v49, v70, v71
    v_exp_f32 v74, v74
    v_exp_f32 v75, v75
    v_cvt_pk_bf16_f32 v50, v72, v73
    v_cvt_pk_bf16_f32 v51, v74, v75
    s_waitcnt lgkmcnt(0)
    ds_read_b128 v[20:23], v1 offset:18368
    ds_read_b64 v[24:25], v2 offset:18368
    ds_read_b128 v[36:39], v3 offset:13120
    ds_read_b128 v[40:43], v3 offset:13792
    v_mfma_f32_32x32x16_bf16 v[60:75], v[12:15], v[4:7], v[108:123]
    v_exp_f32 v76, v76
    v_exp_f32 v77, v77
    v_exp_f32 v78, v78
    v_exp_f32 v79, v79
    v_mfma_f32_32x32x16_bf16 v[92:107], v[28:31], v[44:47], v[92:107]
    v_exp_f32 v80, v80
    v_cvt_pk_bf16_f32 v52, v76, v77
    v_exp_f32 v81, v81
    v_cvt_pk_bf16_f32 v53, v78, v79
    v_exp_f32 v82, v82
    v_exp_f32 v83, v83
    v_mfma_f32_32x32x8_bf16 v[60:75], v[16:17], v[8:9], v[60:75]
    v_exp_f32 v84, v84
    v_cvt_pk_bf16_f32 v54, v80, v81
    v_exp_f32 v85, v85
    v_cvt_pk_bf16_f32 v55, v82, v83
    v_exp_f32 v86, v86
    v_exp_f32 v87, v87
    v_mfma_f32_32x32x16_bf16 v[92:107], v[32:35], v[48:51], v[92:107]
    v_exp_f32 v88, v88
    v_cvt_pk_bf16_f32 v56, v84, v85
    v_exp_f32 v89, v89
    v_cvt_pk_bf16_f32 v57, v86, v87
    v_exp_f32 v90, v90
    v_exp_f32 v91, v91
    v_cvt_pk_bf16_f32 v58, v88, v89
    v_cvt_pk_bf16_f32 v59, v90, v91
    s_cmp_eq_u32 s74, 1
    s_cbranch_scc0 K2_NOB2
    s_barrier
K2_NOB2:
    s_min_u32 s63, s52, 4
    s_sub_u32 s62, s52, s63
    s_mul_i32 s62, s62, 160
    s_add_u32 s62, s62, s63
    s_mul_i32 s63, s56, 5
    s_add_u32 s62, s62, s63
    s_add_u32 s62, s62, 160
    s_lshl_b32 s62, s62, 10
    s_add_u32 s62, s62, 11047936
    buffer_load_dwordx4 v[136:139], v1, s[48:51], s62 offen sc1
    s_add_u32 s62, s62, 20480
    buffer_load_dwordx4 v[140:143], v1, s[48:51], s62 offen sc1
    s_add_u32 s62, s62, 20480
    buffer_load_dwordx4 v[144:147], v1, s[48:51], s62 offen sc1
    s_add_u32 s62, s62, 20480
    buffer_load_dwordx4 v[148:151], v1, s[48:51], s62 offen sc1
    s_add_u32 s62, s62, 20480
    buffer_load_dwordx4 v[152:155], v1, s[48:51], s62 offen sc1
    s_add_u32 s62, s62, 20480
    buffer_load_dwordx4 v[156:159], v1, s[48:51], s62 offen sc1
    s_add_u32 s62, s62, 20480
    buffer_load_dwordx4 v[160:163], v1, s[48:51], s62 offen sc1
    s_add_u32 s62, s62, 20480
    buffer_load_dwordx4 v[164:167], v1, s[48:51], s62 offen sc1
    s_add_u32 s62, s62, 20480
    s_mov_b32 s73, 0
    s_or_b32 s72, s74, 48
K2_LOOP:
    s_waitcnt lgkmcnt(0)
    ds_read_b128 v[12:15], v1 offset:20992
    ds_read_b64 v[16:17], v2 offset:20992
    ds_read_b128 v[28:31], v3 offset:15744
    ds_read_b128 v[32:35], v3 offset:16416
    v_mfma_f32_32x32x16_bf16 v[76:91], v[20:23], v[4:7], v[108:123]
    v_exp_f32 v60, v60
    v_exp_f32 v61, v61
    v_exp_f32 v62, v62
    v_exp_f32 v63, v63
    v_mfma_f32_32x32x16_bf16 v[92:107], v[36:39], v[52:55], v[92:107]
    v_exp_f32 v64, v64
    v_cvt_pk_bf16_f32 v44, v60, v61
    v_exp_f32 v65, v65
    v_cvt_pk_bf16_f32 v45, v62, v63
    v_exp_f32 v66, v66
    v_exp_f32 v67, v67
    v_mfma_f32_32x32x8_bf16 v[76:91], v[24:25], v[8:9], v[76:91]
    v_exp_f32 v68, v68
    v_cvt_pk_bf16_f32 v46, v64, v65
    v_exp_f32 v69, v69
    v_cvt_pk_bf16_f32 v47, v66, v67
    v_exp_f32 v70, v70
    v_exp_f32 v71, v71
    v_mfma_f32_32x32x16_bf16 v[92:107], v[40:43], v[56:59], v[92:107]
    v_exp_f32 v72, v72
    v_cvt_pk_bf16_f32 v48, v68, v69
    v_exp_f32 v73, v73
    v_cvt_pk_bf16_f32 v49, v70, v71
    v_exp_f32 v74, v74
    v_exp_f32 v75, v75
    v_cvt_pk_bf16_f32 v50, v72, v73
    v_cvt_pk_bf16_f32 v51, v74, v75
    s_waitcnt lgkmcnt(0)
    ds_read_b128 v[20:23], v1 offset:23616
    ds_read_b64 v[24:25], v2 offset:23616
    ds_read_b128 v[36:39], v3 offset:18368
    ds_read_b128 v[40:43], v3 offset:19040
    v_mfma_f32_32x32x16_bf16 v[60:75], v[12:15], v[4:7], v[108:123]
    v_exp_f32 v76, v76
    v_exp_f32 v77, v77
    v_exp_f32 v78, v78
    v_exp_f32 v79, v79
    v_mfma_f32_32x32x16_bf16 v[92:107], v[28:31], v[44:47], v[92:107]
    v_exp_f32 v80, v80
    v_cvt_pk_bf16_f32 v52, v76, v77
    v_exp_f32 v81, v81
    v_cvt_pk_bf16_f32 v53, v78, v79
    v_exp_f32 v82, v82
    v_exp_f32 v83, v83
    v_mfma_f32_32x32x8_bf16 v[60:75], v[16:17], v[8:9], v[60:75]
    v_exp_f32 v84, v84
    v_cvt_pk_bf16_f32 v54, v80, v81
    v_exp_f32 v85, v85
    v_cvt_pk_bf16_f32 v55, v82, v83
    v_exp_f32 v86, v86
    v_exp_f32 v87, v87
    v_mfma_f32_32x32x16_bf16 v[92:107], v[32:35], v[48:51], v[92:107]
    v_exp_f32 v88, v88
    v_cvt_pk_bf16_f32 v56, v84, v85
    v_exp_f32 v89, v89
    v_cvt_pk_bf16_f32 v57, v86, v87
    v_exp_f32 v90, v90
    v_exp_f32 v91, v91
    v_cvt_pk_bf16_f32 v58, v88, v89
    v_cvt_pk_bf16_f32 v59, v90, v91
    s_waitcnt lgkmcnt(0)
    ds_read_b128 v[12:15], v1 offset:26240
    ds_read_b64 v[16:17], v2 offset:26240
    ds_read_b128 v[28:31], v3 offset:20992
    ds_read_b128 v[32:35], v3 offset:21664
    v_mfma_f32_32x32x16_bf16 v[76:91], v[20:23], v[4:7], v[108:123]
    v_exp_f32 v60, v60
    v_exp_f32 v61, v61
    v_exp_f32 v62, v62
    v_exp_f32 v63, v63
    v_mfma_f32_32x32x16_bf16 v[92:107], v[36:39], v[52:55], v[92:107]
    v_exp_f32 v64, v64
    v_cvt_pk_bf16_f32 v44, v60, v61
    v_exp_f32 v65, v65
    v_cvt_pk_bf16_f32 v45, v62, v63
    v_exp_f32 v66, v66
    v_exp_f32 v67, v67
    v_mfma_f32_32x32x8_bf16 v[76:91], v[24:25], v[8:9], v[76:91]
    v_exp_f32 v68, v68
    v_cvt_pk_bf16_f32 v46, v64, v65
    v_exp_f32 v69, v69
    v_cvt_pk_bf16_f32 v47, v66, v67
    v_exp_f32 v70, v70
    v_exp_f32 v71, v71
    v_mfma_f32_32x32x16_bf16 v[92:107], v[40:43], v[56:59], v[92:107]
    v_exp_f32 v72, v72
    v_cvt_pk_bf16_f32 v48, v68, v69
    v_exp_f32 v73, v73
    v_cvt_pk_bf16_f32 v49, v70, v71
    v_exp_f32 v74, v74
    v_exp_f32 v75, v75
    v_cvt_pk_bf16_f32 v50, v72, v73
    v_cvt_pk_bf16_f32 v51, v74, v75
    s_waitcnt lgkmcnt(0)
    ds_read_b128 v[20:23], v1 offset:28864
    ds_read_b64 v[24:25], v2 offset:28864
    ds_read_b128 v[36:39], v3 offset:23616
    ds_read_b128 v[40:43], v3 offset:24288
    v_mfma_f32_32x32x16_bf16 v[60:75], v[12:15], v[4:7], v[108:123]
    v_exp_f32 v76, v76
    v_exp_f32 v77, v77
    v_exp_f32 v78, v78
    v_exp_f32 v79, v79
    v_mfma_f32_32x32x16_bf16 v[92:107], v[28:31], v[44:47], v[92:107]
    v_exp_f32 v80, v80
    v_cvt_pk_bf16_f32 v52, v76, v77
    v_exp_f32 v81, v81
    v_cvt_pk_bf16_f32 v53, v78, v79
    v_exp_f32 v82, v82
    v_exp_f32 v83, v83
    v_mfma_f32_32x32x8_bf16 v[60:75], v[16:17], v[8:9], v[60:75]
    v_exp_f32 v84, v84
    v_cvt_pk_bf16_f32 v54, v80, v81
    v_exp_f32 v85, v85
    v_cvt_pk_bf16_f32 v55, v82, v83
    v_exp_f32 v86, v86
    v_exp_f32 v87, v87
    v_mfma_f32_32x32x16_bf16 v[92:107], v[32:35], v[48:51], v[92:107]
    v_exp_f32 v88, v88
    v_cvt_pk_bf16_f32 v56, v84, v85
    v_exp_f32 v89, v89
    v_cvt_pk_bf16_f32 v57, v86, v87
    v_exp_f32 v90, v90
    v_exp_f32 v91, v91
    v_cvt_pk_bf16_f32 v58, v88, v89
    v_cvt_pk_bf16_f32 v59, v90, v91
    s_waitcnt lgkmcnt(0)
    ds_read_b128 v[12:15], v1 offset:31488
    ds_read_b64 v[16:17], v2 offset:31488
    ds_read_b128 v[28:31], v3 offset:26240
    ds_read_b128 v[32:35], v3 offset:26912
    v_mfma_f32_32x32x16_bf16 v[76:91], v[20:23], v[4:7], v[108:123]
    v_exp_f32 v60, v60
    v_exp_f32 v61, v61
    v_exp_f32 v62, v62
    v_exp_f32 v63, v63
    v_mfma_f32_32x32x16_bf16 v[92:107], v[36:39], v[52:55], v[92:107]
    v_exp_f32 v64, v64
    v_cvt_pk_bf16_f32 v44, v60, v61
    v_exp_f32 v65, v65
    v_cvt_pk_bf16_f32 v45, v62, v63
    v_exp_f32 v66, v66
    v_exp_f32 v67, v67
    v_mfma_f32_32x32x8_bf16 v[76:91], v[24:25], v[8:9], v[76:91]
    v_exp_f32 v68, v68
    v_cvt_pk_bf16_f32 v46, v64, v65
    v_exp_f32 v69, v69
    v_cvt_pk_bf16_f32 v47, v66, v67
    v_exp_f32 v70, v70
    v_exp_f32 v71, v71
    v_mfma_f32_32x32x16_bf16 v[92:107], v[40:43], v[56:59], v[92:107]
    v_exp_f32 v72, v72
    v_cvt_pk_bf16_f32 v48, v68, v69
    v_exp_f32 v73, v73
    v_cvt_pk_bf16_f32 v49, v70, v71
    v_exp_f32 v74, v74
    v_exp_f32 v75, v75
    v_cvt_pk_bf16_f32 v50, v72, v73
    v_cvt_pk_bf16_f32 v51, v74, v75
    s_waitcnt lgkmcnt(0)
    ds_read_b128 v[20:23], v1 offset:34112
    ds_read_b64 v[24:25], v2 offset:34112
    ds_read_b128 v[36:39], v3 offset:28864
    ds_read_b128 v[40:43], v3 offset:29536
    v_mfma_f32_32x32x16_bf16 v[60:75], v[12:15], v[4:7], v[108:123]
    v_exp_f32 v76, v76
    v_exp_f32 v77, v77
    v_exp_f32 v78, v78
    v_exp_f32 v79, v79
    v_mfma_f32_32x32x16_bf16 v[92:107], v[28:31], v[44:47], v[92:107]
    v_exp_f32 v80, v80
    v_cvt_pk_bf16_f32 v52, v76, v77
    v_exp_f32 v81, v81
    v_cvt_pk_bf16_f32 v53, v78, v79
    v_exp_f32 v82, v82
    v_exp_f32 v83, v83
    v_mfma_f32_32x32x8_bf16 v[60:75], v[16:17], v[8:9], v[60:75]
    v_exp_f32 v84, v84
    v_cvt_pk_bf16_f32 v54, v80, v81
    v_exp_f32 v85, v85
    v_cvt_pk_bf16_f32 v55, v82, v83
    v_exp_f32 v86, v86
    v_exp_f32 v87, v87
    v_mfma_f32_32x32x16_bf16 v[92:107], v[32:35], v[48:51], v[92:107]
    v_exp_f32 v88, v88
    v_cvt_pk_bf16_f32 v56, v84, v85
    v_exp_f32 v89, v89
    v_cvt_pk_bf16_f32 v57, v86, v87
    v_exp_f32 v90, v90
    v_exp_f32 v91, v91
    v_cvt_pk_bf16_f32 v58, v88, v89
    v_cvt_pk_bf16_f32 v59, v90, v91
    s_waitcnt lgkmcnt(0)
    ds_read_b128 v[12:15], v1 offset:36736
    ds_read_b64 v[16:17], v2 offset:36736
    ds_read_b128 v[28:31], v3 offset:31488
    ds_read_b128 v[32:35], v3 offset:32160
    v_mfma_f32_32x32x16_bf16 v[76:91], v[20:23], v[4:7], v[108:123]
    v_exp_f32 v60, v60
    v_exp_f32 v61, v61
    v_exp_f32 v62, v62
    v_exp_f32 v63, v63
    v_mfma_f32_32x32x16_bf16 v[92:107], v[36:39], v[52:55], v[92:107]
    v_exp_f32 v64, v64
    v_cvt_pk_bf16_f32 v44, v60, v61
    v_exp_f32 v65, v65
    v_cvt_pk_bf16_f32 v45, v62, v63
    v_exp_f32 v66, v66
    v_exp_f32 v67, v67
    v_mfma_f32_32x32x8_bf16 v[76:91], v[24:25], v[8:9], v[76:91]
    v_exp_f32 v68, v68
    v_cvt_pk_bf16_f32 v46, v64, v65
    v_exp_f32 v69, v69
    v_cvt_pk_bf16_f32 v47, v66, v67
    v_exp_f32 v70, v70
    v_exp_f32 v71, v71
    v_mfma_f32_32x32x16_bf16 v[92:107], v[40:43], v[56:59], v[92:107]
    v_exp_f32 v72, v72
    v_cvt_pk_bf16_f32 v48, v68, v69
    v_exp_f32 v73, v73
    v_cvt_pk_bf16_f32 v49, v70, v71
    v_exp_f32 v74, v74
    v_exp_f32 v75, v75
    v_cvt_pk_bf16_f32 v50, v72, v73
    v_cvt_pk_bf16_f32 v51, v74, v75
    s_waitcnt lgkmcnt(0)
    ds_read_b128 v[20:23], v1 offset:39360
    ds_read_b64 v[24:25], v2 offset:39360
    ds_read_b128 v[36:39], v3 offset:34112
    ds_read_b128 v[40:43], v3 offset:34784
    v_mfma_f32_32x32x16_bf16 v[60:75], v[12:15], v[4:7], v[108:123]
    v_exp_f32 v76, v76
    v_exp_f32 v77, v77
    v_exp_f32 v78, v78
    v_exp_f32 v79, v79
    v_mfma_f32_32x32x16_bf16 v[92:107], v[28:31], v[44:47], v[92:107]
    v_exp_f32 v80, v80
    v_cvt_pk_bf16_f32 v52, v76, v77
    v_exp_f32 v81, v81
    v_cvt_pk_bf16_f32 v53, v78, v79
    v_exp_f32 v82, v82
    v_exp_f32 v83, v83
    v_mfma_f32_32x32x8_bf16 v[60:75], v[16:17], v[8:9], v[60:75]
    v_exp_f32 v84, v84
    v_cvt_pk_bf16_f32 v54, v80, v81
    v_exp_f32 v85, v85
    v_cvt_pk_bf16_f32 v55, v82, v83
    v_exp_f32 v86, v86
    v_exp_f32 v87, v87
    v_mfma_f32_32x32x16_bf16 v[92:107], v[32:35], v[48:51], v[92:107]
    v_exp_f32 v88, v88
    v_cvt_pk_bf16_f32 v56, v84, v85
    v_exp_f32 v89, v89
    v_cvt_pk_bf16_f32 v57, v86, v87
    v_exp_f32 v90, v90
    v_exp_f32 v91, v91
    v_cvt_pk_bf16_f32 v58, v88, v89
    v_cvt_pk_bf16_f32 v59, v90, v91
    v_add_u32 v1, 20992, v1
    v_add_u32 v2, 20992, v2
    v_add_u32 v3, 20992, v3
    s_bitcmp1_b32 s72, s73
    s_cbranch_scc0 K2_NOBAR
    s_barrier
K2_NOBAR:
    s_add_u32 s73, s73, 1
    s_cmp_lg_u32 s73, 7
    s_cbranch_scc1 K2_LOOP
    s_waitcnt lgkmcnt(0)
    v_mfma_f32_32x32x16_bf16 v[92:107], v[36:39], v[52:55], v[92:107]
    v_mfma_f32_32x32x16_bf16 v[92:107], v[40:43], v[56:59], v[92:107]
    v_lshlrev_b32 v129, 10, v127
    v_lshl_add_u32 v129, v128, 9, v129
    v_lshl_add_u32 v129, v126, 4, v129
    s_mul_i32 s61, s55, 40960
    s_add_u32 s61, s61, 11867136
    s_lshl_b32 s63, s52, 12
    s_add_u32 s62, s61, s63
    v_lshrrev_b32 v134, 1, v127
    v_lshlrev_b32 v134, 10, v134
    v_and_b32 v135, 1, v127
    v_lshl_add_u32 v134, v135, 9, v134
    v_lshl_add_u32 v134, v126, 4, v134
    s_lshr_b32 s64, s52, 1
    s_lshl_b32 s64, s64, 11
    s_add_u32 s64, s64, s61
    s_add_u32 s64, s64, 32768
    s_and_b32 s63, s52, 1
    s_lshl_b32 s63, s63, 3
    s_add_u32 s64, s64, s63
    v_rcp_f32 v130, v104
    s_nop 0
    v_mul_f32 v92, v130, v92
    v_mul_f32 v93, v130, v93
    v_mul_f32 v94, v130, v94
    v_mul_f32 v95, v130, v95
    v_mul_f32 v96, v130, v96
    v_mul_f32 v97, v130, v97
    v_mul_f32 v98, v130, v98
    v_mul_f32 v99, v130, v99
    v_mul_f32 v100, v130, v100
    v_mul_f32 v101, v130, v101
    v_mul_f32 v102, v130, v102
    v_mul_f32 v103, v130, v103
    v_cvt_pk_bf16_f32 v60, v92, v93
    v_cvt_pk_bf16_f32 v61, v94, v95
    v_cvt_pk_bf16_f32 v62, v96, v97
    v_cvt_pk_bf16_f32 v63, v98, v99
    v_cvt_pk_bf16_f32 v64, v100, v101
    v_cvt_pk_bf16_f32 v65, v102, v103
    buffer_store_dwordx4 v[60:63], v129, s[48:51], s62 offen sc0 sc1
    v_cmp_gt_u32 vcc, 32, v0
    s_nop 0
    s_and_saveexec_b64 s[78:79], vcc
    buffer_store_dwordx2 v[64:65], v134, s[48:51], s64 offen sc0 sc1
    s_mov_b64 exec, -1
    v_lshlrev_b32 v1, 4, v0
    s_waitcnt vmcnt(0)
    s_barrier
    s_cmp_lg_u32 s52, 0
    s_cbranch_scc1 K2_FLAGOK
    s_lshl_b32 s63, s55, 7
    s_add_u32 s63, s63, 19883008
    s_lshl_b32 s62, s56, 2
    s_add_u32 s62, s62, s63
    v_and_b32 v3, 3, v0
    v_lshlrev_b32 v3, 2, v3
    s_mov_b64 exec, 1
    v_mov_b32 v2, s3
    s_nop 1
    buffer_store_dword v2, v3, s[48:51], s62 offen sc0 sc1
    s_mov_b64 exec, -1
K2_POLL:
    buffer_load_dword v2, v3, s[48:51], s63 offen sc1
    s_waitcnt vmcnt(0)
    v_cmp_eq_u32 vcc, s3, v2
    s_nop 3
    s_cmp_eq_u64 vcc, exec
    s_cbranch_scc1 K2_FLAGOK
    s_sleep 1
    s_branch K2_POLL
K2_FLAGOK:
    s_nop 0
    s_barrier
    s_lshl_b32 s62, s52, 10
    s_add_u32 s63, s62, s61
    s_add_u32 s62, s62, 122880
    s_mov_b32 m0, s62
    s_add_u32 s62, s62, 8192
    buffer_load_dwordx4 v1, s[48:51], s63 offen sc1 lds
    s_add_u32 s63, s63, 8192
    s_mov_b32 m0, s62
    s_add_u32 s62, s62, 8192
    buffer_load_dwordx4 v1, s[48:51], s63 offen sc1 lds
    s_add_u32 s63, s63, 8192
    s_mov_b32 m0, s62
    s_add_u32 s62, s62, 8192
    buffer_load_dwordx4 v1, s[48:51], s63 offen sc1 lds
    s_add_u32 s63, s63, 8192
    s_mov_b32 m0, s62
    s_add_u32 s62, s62, 8192
    buffer_load_dwordx4 v1, s[48:51], s63 offen sc1 lds
    s_add_u32 s63, s63, 8192
    s_mov_b32 m0, s62
    s_add_u32 s62, s62, 8192
    buffer_load_dwordx4 v1, s[48:51], s63 offen sc1 lds
    s_add_u32 s63, s63, 8192
    v_add_u32 v2, 122880, v1
    s_min_u32 s63, s52, 4
    s_sub_u32 s62, s52, s63
    s_mul_i32 s64, s62, 10240
    s_lshl_b32 s63, s63, 10
    s_add_u32 s64, s64, s63
    s_add_u32 s64, s64, 81920
    v_add_u32 v3, s64, v1
    s_waitcnt vmcnt(0)
    s_barrier
    s_cmp_ge_u32 s52, 4
    s_cbranch_scc1 K2_P2B
    ds_read_b128 v[12:15], v2 offset:8192
    ds_read_b128 v[16:19], v2 offset:9216
    ds_read_b128 v[20:23], v2 offset:10240
    ds_read_b128 v[24:27], v2 offset:11264
    ds_read_b128 v[28:31], v2 offset:12288
    ds_read_b128 v[32:35], v2 offset:13312
    ds_read_b128 v[36:39], v2 offset:14336
    ds_read_b128 v[40:43], v2 offset:15360
    ds_read_b128 v[44:47], v3 offset:0
    ds_read_b128 v[76:79], v2 offset:0
    ds_read_b128 v[48:51], v3 offset:5120
    ds_read_b128 v[80:83], v2 offset:1024
    ds_read_b128 v[52:55], v3 offset:10240
    ds_read_b128 v[84:87], v2 offset:2048
    ds_read_b128 v[56:59], v3 offset:15360
    ds_read_b128 v[88:91], v2 offset:3072
    s_waitcnt lgkmcnt(15)
    v_mfma_f32_32x32x16_bf16 v[60:75], v[136:139], v[12:15], 0
    s_waitcnt lgkmcnt(14)
    v_mfma_f32_32x32x16_bf16 v[60:75], v[140:143], v[16:19], v[60:75]
    s_waitcnt lgkmcnt(13)
    v_mfma_f32_32x32x16_bf16 v[60:75], v[144:147], v[20:23], v[60:75]
    s_waitcnt lgkmcnt(12)
    v_mfma_f32_32x32x16_bf16 v[60:75], v[148:151], v[24:27], v[60:75]
    s_waitcnt lgkmcnt(11)
    v_mfma_f32_32x32x16_bf16 v[60:75], v[152:155], v[28:31], v[60:75]
    ds_read_b128 v[92:95], v3 offset:20480
    ds_read_b128 v[108:111], v2 offset:4096
    s_waitcnt lgkmcnt(12)
    v_mfma_f32_32x32x16_bf16 v[60:75], v[156:159], v[32:35], v[60:75]
    ds_read_b128 v[96:99], v3 offset:25600
    ds_read_b128 v[112:115], v2 offset:5120
    s_waitcnt lgkmcnt(13)
    v_mfma_f32_32x32x16_bf16 v[60:75], v[160:163], v[36:39], v[60:75]
    ds_read_b128 v[100:103], v3 offset:30720
    ds_read_b128 v[116:119], v2 offset:6144
    s_waitcnt lgkmcnt(14)
    v_mfma_f32_32x32x16_bf16 v[60:75], v[164:167], v[40:43], v[60:75]
    ds_read_b128 v[104:107], v3 offset:35840
    ds_read_b128 v[120:123], v2 offset:7168
    s_waitcnt lgkmcnt(14)
    v_mfma_f32_32x32x16_bf16 v[60:75], v[44:47], v[76:79], v[60:75]
    s_waitcnt lgkmcnt(12)
    v_mfma_f32_32x32x16_bf16 v[60:75], v[48:51], v[80:83], v[60:75]
    s_waitcnt lgkmcnt(10)
    v_mfma_f32_32x32x16_bf16 v[60:75], v[52:55], v[84:87], v[60:75]
    s_waitcnt lgkmcnt(8)
    v_mfma_f32_32x32x16_bf16 v[60:75], v[56:59], v[88:91], v[60:75]
    s_waitcnt lgkmcnt(6)
    v_mfma_f32_32x32x16_bf16 v[60:75], v[92:95], v[108:111], v[60:75]
    s_waitcnt lgkmcnt(4)
    v_mfma_f32_32x32x16_bf16 v[60:75], v[96:99], v[112:115], v[60:75]
    s_waitcnt lgkmcnt(2)
    v_mfma_f32_32x32x16_bf16 v[60:75], v[100:103], v[116:119], v[60:75]
    s_waitcnt lgkmcnt(0)
    v_mfma_f32_32x32x16_bf16 v[60:75], v[104:107], v[120:123], v[60:75]
    s_lshl_b32 s63, s52, 13
    s_branch K2_P2W
K2_P2B:
    s_lshl_b32 s63, s62, 13
    v_add_u32 v4, s63, v2
    s_lshl_b32 s63, s62, 11
    v_add_u32 v5, s63, v2
    ds_read_b128 v[12:15], v4 offset:8192
    ds_read_b128 v[16:19], v4 offset:9216
    ds_read_b128 v[20:23], v4 offset:10240
    ds_read_b128 v[24:27], v4 offset:11264
    ds_read_b128 v[28:31], v4 offset:12288
    ds_read_b128 v[32:35], v4 offset:13312
    ds_read_b128 v[36:39], v4 offset:14336
    ds_read_b128 v[40:43], v4 offset:15360
    ds_read_b128 v[44:47], v3 offset:0
    ds_read_b128 v[76:79], v5 offset:0
    ds_read_b128 v[48:51], v3 offset:5120
    ds_read_b128 v[80:83], v5 offset:1024
    s_waitcnt lgkmcnt(11)
    v_mfma_f32_32x32x16_bf16 v[60:75], v[136:139], v[12:15], 0
    s_waitcnt lgkmcnt(10)
    v_mfma_f32_32x32x16_bf16 v[60:75], v[140:143], v[16:19], v[60:75]
    s_waitcnt lgkmcnt(9)
    v_mfma_f32_32x32x16_bf16 v[60:75], v[144:147], v[20:23], v[60:75]
    s_waitcnt lgkmcnt(8)
    v_mfma_f32_32x32x16_bf16 v[60:75], v[148:151], v[24:27], v[60:75]
    s_waitcnt lgkmcnt(7)
    v_mfma_f32_32x32x16_bf16 v[60:75], v[152:155], v[28:31], v[60:75]
    s_waitcnt lgkmcnt(6)
    v_mfma_f32_32x32x16_bf16 v[60:75], v[156:159], v[32:35], v[60:75]
    s_waitcnt lgkmcnt(5)
    v_mfma_f32_32x32x16_bf16 v[60:75], v[160:163], v[36:39], v[60:75]
    s_waitcnt lgkmcnt(4)
    v_mfma_f32_32x32x16_bf16 v[60:75], v[164:167], v[40:43], v[60:75]
    s_waitcnt lgkmcnt(2)
    v_mfma_f32_32x32x16_bf16 v[60:75], v[44:47], v[76:79], v[60:75]
    s_waitcnt lgkmcnt(0)
    v_mfma_f32_32x32x16_bf16 v[60:75], v[48:51], v[80:83], v[60:75]
    s_lshl_b32 s63, s62, 12
    s_add_u32 s63, s63, 32768
K2_P2W:
    s_nop 9
    v_add_u32 v2, s63, v1
    ds_write_b128 v2, v[60:63] offset:0
    ds_write_b128 v2, v[64:67] offset:1024
    ds_write_b128 v2, v[68:71] offset:2048
    ds_write_b128 v2, v[72:75] offset:3072
    s_waitcnt lgkmcnt(0)
    s_barrier
    s_branch K2_END
PB_G:
    v_mov_b32 v5, 0
PB_NC:
    buffer_load_dword v4, v5, s[72:75], 0 offen sc1
    s_waitcnt vmcnt(0)
    v_readfirstlane_b32 s3, v4
    s_nop 3
    s_cmp_lg_u32 s3, 0
    s_cbranch_scc1 PB_NC_OK
    s_sleep 2
    s_branch PB_NC
PB_NC_OK:
    v_and_b32 v3, 7, v0
    v_lshlrev_b32 v3, 2, v3
    s_mov_b32 s27, 19879936
    buffer_load_dword v4, v3, s[48:51], s27 offen sc1
    s_waitcnt vmcnt(0)
PB_G2:
    s_nop 0
    s_load_dwordx2 s[16:17], s[0:1], 0
    s_load_dwordx2 s[18:19], s[0:1], 72
    s_and_b32 s63, s2, 7
    s_lshr_b32 s67, s2, 3
    s_lshl_b32 s55, s63, 3
    s_lshr_b32 s68, s67, 2
    s_add_u32 s55, s55, s68
    s_and_b32 s56, s67, 3
    v_cmp_eq_u32 vcc, s3, v4
    s_nop 3
    s_cmp_eq_u64 vcc, exec
    s_cselect_b32 s74, 1, 0
    s_waitcnt lgkmcnt(0)
    s_mov_b32 s36, s16
    s_mov_b32 s37, s17
    s_mov_b32 s38, 2621440
    s_mov_b32 s39, 0x00020000
    s_sub_u32 s53, s52, 8
    v_lshlrev_b32 v1, 4, v0
    v_add_u32 v2, 4096, v1
    s_mul_i32 s60, s55, 98304
    s_mul_i32 s63, s53, 24576
    s_add_u32 s60, s60, s63
    s_add_u32 s60, s60, 2621440
    s_mul_i32 s61, s53, 491520
    s_mul_i32 s63, s56, 5120
    s_add_u32 s61, s61, s63
    s_add_u32 s61, s61, 9081856
    s_lshl_b32 s62, s53, 10
    s_add_u32 s63, s62, 8918144
    s_barrier
    s_cmp_eq_u32 s74, 0
    s_cbranch_scc1 PB_NR1
    s_mov_b32 m0, s62
    s_add_u32 s62, s62, 4096
    buffer_load_dwordx4 v1, s[48:51], s63 offen sc1 lds
    s_add_u32 s63, s63, 4096
    s_mov_b32 m0, s62
    s_add_u32 s62, s62, 4096
    buffer_load_dwordx4 v1, s[48:51], s63 offen sc1 lds
    s_add_u32 s63, s63, 4096
    s_mov_b32 m0, s62
    s_add_u32 s62, s62, 4096
    buffer_load_dwordx4 v1, s[48:51], s63 offen sc1 lds
    s_add_u32 s63, s63, 4096
    s_mov_b32 m0, s62
    s_add_u32 s62, s62, 4096
    buffer_load_dwordx4 v1, s[48:51], s63 offen sc1 lds
    s_add_u32 s63, s63, 4096
    s_mov_b32 m0, s62
    s_add_u32 s62, s62, 4096
    buffer_load_dwordx4 v1, s[48:51], s63 offen sc1 lds
    s_add_u32 s63, s63, 4096
    s_mov_b32 m0, s62
    s_add_u32 s62, s62, 4096
    buffer_load_dwordx4 v1, s[48:51], s63 offen sc1 lds
    s_add_u32 s63, s63, 4096
    s_mov_b32 m0, s62
    s_add_u32 s62, s62, 4096
    buffer_load_dwordx4 v1, s[48:51], s63 offen sc1 lds
    s_add_u32 s63, s63, 4096
    s_mov_b32 m0, s62
    s_add_u32 s62, s62, 4096
    buffer_load_dwordx4 v1, s[48:51], s63 offen sc1 lds
    s_add_u32 s63, s63, 4096
    s_mov_b32 m0, s62
    s_add_u32 s62, s62, 4096
    buffer_load_dwordx4 v1, s[48:51], s63 offen sc1 lds
    s_add_u32 s63, s63, 4096
    s_mov_b32 m0, s62
    s_add_u32 s62, s62, 4096
    buffer_load_dwordx4 v1, s[48:51], s63 offen sc1 lds
    s_add_u32 s63, s63, 4096
    s_mov_b32 m0, s62
    s_add_u32 s62, s62, 4096
    buffer_load_dwordx4 v1, s[48:51], s63 offen sc1 lds
    s_add_u32 s63, s63, 4096
    s_mov_b32 m0, s62
    s_add_u32 s62, s62, 4096
    buffer_load_dwordx4 v1, s[48:51], s63 offen sc1 lds
    s_add_u32 s63, s63, 4096
    s_mov_b32 m0, s62
    s_add_u32 s62, s62, 4096
    buffer_load_dwordx4 v1, s[48:51], s63 offen sc1 lds
    s_add_u32 s63, s63, 4096
    s_mov_b32 m0, s62
    s_add_u32 s62, s62, 4096
    buffer_load_dwordx4 v1, s[48:51], s63 offen sc1 lds
    s_add_u32 s63, s63, 4096
    s_mov_b32 m0, s62
    s_add_u32 s62, s62, 4096
    buffer_load_dwordx4 v1, s[48:51], s63 offen sc1 lds
    s_add_u32 s63, s63, 4096
    s_mov_b32 m0, s62
    s_add_u32 s62, s62, 4096
    buffer_load_dwordx4 v1, s[48:51], s63 offen sc1 lds
    s_add_u32 s63, s63, 4096
PB_NR1:
    s_barrier
    s_cmp_eq_u32 s74, 1
    s_cbranch_scc1 PB_R2
    s_mov_b32 m0, s62
    s_add_u32 s62, s62, 4096
    buffer_load_dwordx4 v1, s[48:51], s63 offen sc1 lds
    s_add_u32 s63, s63, 4096
    s_mov_b32 m0, s62
    s_add_u32 s62, s62, 4096
    buffer_load_dwordx4 v1, s[48:51], s63 offen sc1 lds
    s_add_u32 s63, s63, 4096
    s_mov_b32 m0, s62
    s_add_u32 s62, s62, 4096
    buffer_load_dwordx4 v1, s[48:51], s63 offen sc1 lds
    s_add_u32 s63, s63, 4096
    s_mov_b32 m0, s62
    s_add_u32 s62, s62, 4096
    buffer_load_dwordx4 v1, s[48:51], s63 offen sc1 lds
    s_add_u32 s63, s63, 4096
    s_mov_b32 m0, s62
    s_add_u32 s62, s62, 4096
    buffer_load_dwordx4 v1, s[48:51], s63 offen sc1 lds
    s_add_u32 s63, s63, 4096
    s_mov_b32 m0, s62
    s_add_u32 s62, s62, 4096
    buffer_load_dwordx4 v1, s[48:51], s63 offen sc1 lds
    s_add_u32 s63, s63, 4096
    s_mov_b32 m0, s62
    s_add_u32 s62, s62, 4096
    buffer_load_dwordx4 v1, s[48:51], s63 offen sc1 lds
    s_add_u32 s63, s63, 4096
    s_mov_b32 m0, s62
    s_add_u32 s62, s62, 4096
    buffer_load_dwordx4 v1, s[48:51], s63 offen sc1 lds
    s_add_u32 s63, s63, 4096
    s_mov_b32 m0, s62
    s_add_u32 s62, s62, 4096
    buffer_load_dwordx4 v1, s[48:51], s63 offen sc1 lds
    s_add_u32 s63, s63, 4096
    s_mov_b32 m0, s62
    s_add_u32 s62, s62, 4096
    buffer_load_dwordx4 v1, s[48:51], s63 offen sc1 lds
    s_add_u32 s63, s63, 4096
    s_mov_b32 m0, s62
    s_add_u32 s62, s62, 4096
    buffer_load_dwordx4 v1, s[48:51], s63 offen sc1 lds
    s_add_u32 s63, s63, 4096
    s_mov_b32 m0, s62
    s_add_u32 s62, s62, 4096
    buffer_load_dwordx4 v1, s[48:51], s63 offen sc1 lds
    s_add_u32 s63, s63, 4096
    s_mov_b32 m0, s62
    s_add_u32 s62, s62, 4096
    buffer_load_dwordx4 v1, s[48:51], s63 offen sc1 lds
    s_add_u32 s63, s63, 4096
    s_mov_b32 m0, s62
    s_add_u32 s62, s62, 4096
    buffer_load_dwordx4 v1, s[48:51], s63 offen sc1 lds
    s_add_u32 s63, s63, 4096
    s_mov_b32 m0, s62
    s_add_u32 s62, s62, 4096
    buffer_load_dwordx4 v1, s[48:51], s63 offen sc1 lds
    s_add_u32 s63, s63, 4096
    s_mov_b32 m0, s62
    s_add_u32 s62, s62, 4096
    buffer_load_dwordx4 v1, s[48:51], s63 offen sc1 lds
    s_add_u32 s63, s63, 4096
PB_R2:
    s_barrier
    s_waitcnt vmcnt(10)
    s_barrier
    s_mov_b32 m0, s62
    s_add_u32 s62, s62, 4096
    buffer_load_dwordx4 v1, s[48:51], s63 offen sc1 lds
    s_add_u32 s63, s63, 4096
    s_mov_b32 m0, s62
    s_add_u32 s62, s62, 4096
    buffer_load_dwordx4 v1, s[48:51], s63 offen sc1 lds
    s_add_u32 s63, s63, 4096
    s_mov_b32 m0, s62
    s_add_u32 s62, s62, 4096
    buffer_load_dwordx4 v1, s[48:51], s63 offen sc1 lds
    s_add_u32 s63, s63, 4096
    s_mov_b32 m0, s62
    s_add_u32 s62, s62, 4096
    buffer_load_dwordx4 v1, s[48:51], s63 offen sc1 lds
    s_add_u32 s63, s63, 4096
    s_mov_b32 m0, s62
    s_add_u32 s62, s62, 4096
    buffer_load_dwordx4 v1, s[48:51], s63 offen sc1 lds
    s_add_u32 s63, s63, 4096
    s_mov_b32 m0, s62
    s_add_u32 s62, s62, 4096
    buffer_load_dwordx4 v1, s[48:51], s63 offen sc1 lds
    s_add_u32 s63, s63, 4096
    s_mov_b32 m0, s62
    s_add_u32 s62, s62, 4096
    buffer_load_dwordx4 v1, s[48:51], s63 offen sc1 lds
    s_add_u32 s63, s63, 4096
    s_mov_b32 m0, s62
    s_add_u32 s62, s62, 4096
    buffer_load_dwordx4 v1, s[48:51], s63 offen sc1 lds
    s_add_u32 s63, s63, 4096
    s_mov_b32 m0, s62
    s_add_u32 s62, s62, 4096
    buffer_load_dwordx4 v1, s[48:51], s63 offen sc1 lds
    s_add_u32 s63, s63, 4096
    s_mov_b32 m0, s62
    s_add_u32 s62, s62, 4096
    buffer_load_dwordx4 v1, s[48:51], s63 offen sc1 lds
    s_add_u32 s63, s63, 4096
    s_mov_b32 m0, s62
    s_add_u32 s62, s62, 4096
    buffer_load_dwordx4 v1, s[48:51], s63 offen sc1 lds
    s_add_u32 s63, s63, 4096
    s_mov_b32 m0, s62
    s_add_u32 s62, s62, 4096
    buffer_load_dwordx4 v1, s[48:51], s63 offen sc1 lds
    s_add_u32 s63, s63, 4096
    s_mov_b32 m0, s62
    s_add_u32 s62, s62, 4096
    buffer_load_dwordx4 v1, s[48:51], s63 offen sc1 lds
    s_add_u32 s63, s63, 4096
    s_mov_b32 m0, s62
    s_add_u32 s62, s62, 4096
    buffer_load_dwordx4 v1, s[48:51], s63 offen sc1 lds
    s_add_u32 s63, s63, 4096
    s_mov_b32 m0, s62
    s_add_u32 s62, s62, 4096
    buffer_load_dwordx4 v1, s[48:51], s63 offen sc1 lds
    s_add_u32 s63, s63, 4096
    s_mov_b32 m0, s62
    s_add_u32 s62, s62, 4096
    buffer_load_dwordx4 v1, s[48:51], s63 offen sc1 lds
    s_add_u32 s63, s63, 4096
    s_mov_b32 m0, s62
    s_add_u32 s62, s62, 4096
    buffer_load_dwordx4 v1, s[48:51], s63 offen sc1 lds
    s_add_u32 s63, s63, 4096
    s_mov_b32 m0, s62
    s_add_u32 s62, s62, 4096
    buffer_load_dwordx4 v1, s[48:51], s63 offen sc1 lds
    s_add_u32 s63, s63, 4096
    s_mov_b32 m0, s62
    s_add_u32 s62, s62, 4096
    buffer_load_dwordx4 v1, s[48:51], s63 offen sc1 lds
    s_add_u32 s63, s63, 4096
    s_mov_b32 m0, s62
    s_add_u32 s62, s62, 4096
    buffer_load_dwordx4 v1, s[48:51], s63 offen sc1 lds
    s_add_u32 s63, s63, 4096
    s_mov_b32 m0, s62
    s_add_u32 s62, s62, 4096
    buffer_load_dwordx4 v1, s[48:51], s63 offen sc1 lds
    s_add_u32 s63, s63, 4096
    s_mov_b32 m0, s62
    s_add_u32 s62, s62, 4096
    buffer_load_dwordx4 v1, s[48:51], s63 offen sc1 lds
    s_add_u32 s63, s63, 4096
    s_mov_b32 m0, s62
    s_add_u32 s62, s62, 4096
    buffer_load_dwordx4 v1, s[48:51], s63 offen sc1 lds
    s_add_u32 s63, s63, 4096
    s_min_u32 s62, s62, 161792
    s_add_u32 s63, s62, 8918144
    s_mov_b32 m0, s62
    s_add_u32 s62, s62, 4096
    buffer_load_dwordx4 v1, s[48:51], s63 offen sc1 lds
    s_add_u32 s63, s63, 4096
    v_mov_b32 v4, 0
    v_mov_b32 v5, 0
    v_mov_b32 v6, 0
    v_mov_b32 v7, 0
    v_mov_b32 v8, 0
    v_mov_b32 v9, 0
    v_mov_b32 v10, 0
    v_mov_b32 v11, 0
    v_mov_b32 v12, 0
    v_mov_b32 v13, 0
    v_mov_b32 v14, 0
    v_mov_b32 v15, 0
    v_mov_b32 v16, 0
    v_mov_b32 v17, 0
    v_mov_b32 v18, 0
    v_mov_b32 v19, 0
    v_mov_b32 v20, 0
    v_mov_b32 v21, 0
    v_mov_b32 v22, 0
    v_mov_b32 v23, 0
    v_mov_b32 v24, 0
    v_mov_b32 v25, 0
    v_mov_b32 v26, 0
    v_mov_b32 v27, 0
    v_mov_b32 v28, 0
    v_mov_b32 v29, 0
    v_mov_b32 v30, 0
    v_mov_b32 v31, 0
    v_mov_b32 v32, 0
    v_mov_b32 v33, 0
    v_mov_b32 v34, 0
    v_mov_b32 v35, 0
    v_mov_b32 v36, 0
    v_mov_b32 v37, 0
    v_mov_b32 v38, 0
    v_mov_b32 v39, 0
    v_mov_b32 v40, 0
    v_mov_b32 v41, 0
    v_mov_b32 v42, 0
    v_mov_b32 v43, 0
    v_mov_b32 v44, 0
    v_mov_b32 v45, 0
    v_mov_b32 v46, 0
    v_mov_b32 v47, 0
    v_mov_b32 v48, 0
    v_mov_b32 v49, 0
    v_mov_b32 v50, 0
    v_mov_b32 v51, 0
    v_mov_b32 v52, 0
    v_mov_b32 v53, 0
    v_mov_b32 v54, 0
    v_mov_b32 v55, 0
    v_mov_b32 v56, 0
    v_mov_b32 v57, 0
    v_mov_b32 v58, 0
    v_mov_b32 v59, 0
    v_mov_b32 v60, 0
    v_mov_b32 v61, 0
    v_mov_b32 v62, 0
    v_mov_b32 v63, 0
    v_mov_b32 v64, 0
    v_mov_b32 v65, 0
    v_mov_b32 v66, 0
    v_mov_b32 v67, 0
    v_mov_b32 v68, 0
    v_mov_b32 v69, 0
    v_mov_b32 v70, 0
    v_mov_b32 v71, 0
    v_mov_b32 v72, 0
    v_mov_b32 v73, 0
    v_mov_b32 v74, 0
    v_mov_b32 v75, 0
    v_mov_b32 v76, 0
    v_mov_b32 v77, 0
    v_mov_b32 v78, 0
    v_mov_b32 v79, 0
    v_mov_b32 v80, 0
    v_mov_b32 v81, 0
    v_mov_b32 v82, 0
    v_mov_b32 v83, 0
    s_waitcnt vmcnt(24)
    s_barrier
    s_and_b32 s63, s2, 7
    s_lshl_b32 s63, s63, 7
    v_lshlrev_b32 v3, 2, v0
    v_add_u32 v84, s63, v3
    v_add_u32 v3, 960, v3
    v_cmp_gt_u32 vcc, 24, v0
    s_nop 1
    v_cndmask_b32 v3, v3, v84, vcc
    v_mov_b32 v84, s63
    v_cmp_gt_u32 vcc, 40, v0
    s_nop 1
    v_cndmask_b32 v3, v84, v3, vcc
    s_mov_b32 s27, 19878912
    s_waitcnt vmcnt(0)
    buffer_load_dword v84, v3, s[48:51], s27 offen sc1
    s_barrier
PB_HP:
    s_waitcnt vmcnt(0)
    v_cmp_eq_u32 vcc, s3, v84
    s_nop 3
    s_cmp_eq_u64 vcc, exec
    s_cbranch_scc1 PB_HOK
    s_sleep 1
    buffer_load_dword v84, v3, s[48:51], s27 offen sc1
    s_branch PB_HP
PB_HOK:
    buffer_load_dwordx4 v[84:87], v1, s[48:51], s60 offen sc1
    buffer_load_dwordx4 v[88:91], v1, s[48:51], s61 offen offset:0 sc1
    buffer_load_dwordx4 v[92:95], v1, s[48:51], s61 offen offset:1024 sc1
    buffer_load_dwordx4 v[96:99], v1, s[48:51], s61 offen offset:2048 sc1
    buffer_load_dwordx4 v[100:103], v1, s[48:51], s61 offen offset:3072 sc1
    buffer_load_dwordx4 v[104:107], v2, s[48:51], s61 offen sc1
    s_add_u32 s60, s60, 1024
    s_add_u32 s61, s61, 20480
    buffer_load_dwordx4 v[108:111], v1, s[48:51], s60 offen sc1
    buffer_load_dwordx4 v[112:115], v1, s[48:51], s61 offen offset:0 sc1
    buffer_load_dwordx4 v[116:119], v1, s[48:51], s61 offen offset:1024 sc1
    buffer_load_dwordx4 v[120:123], v1, s[48:51], s61 offen offset:2048 sc1
    buffer_load_dwordx4 v[124:127], v1, s[48:51], s61 offen offset:3072 sc1
    buffer_load_dwordx4 v[128:131], v2, s[48:51], s61 offen sc1
    s_add_u32 s60, s60, 1024
    s_add_u32 s61, s61, 20480
    buffer_load_dwordx4 v[132:135], v1, s[48:51], s60 offen sc1
    buffer_load_dwordx4 v[136:139], v1, s[48:51], s61 offen offset:0 sc1
    buffer_load_dwordx4 v[140:143], v1, s[48:51], s61 offen offset:1024 sc1
    buffer_load_dwordx4 v[144:147], v1, s[48:51], s61 offen offset:2048 sc1
    buffer_load_dwordx4 v[148:151], v1, s[48:51], s61 offen offset:3072 sc1
    buffer_load_dwordx4 v[152:155], v2, s[48:51], s61 offen sc1
    s_add_u32 s60, s60, 1024
    s_add_u32 s61, s61, 20480
    s_mov_b32 s73, 7
K2_GLOOP:
    s_waitcnt vmcnt(12)
    v_mfma_f32_32x32x16_bf16 v[4:19], v[88:91], v[84:87], v[4:19]
    v_mfma_f32_32x32x16_bf16 v[20:35], v[92:95], v[84:87], v[20:35]
    v_mfma_f32_32x32x16_bf16 v[36:51], v[96:99], v[84:87], v[36:51]
    v_mfma_f32_32x32x16_bf16 v[52:67], v[100:103], v[84:87], v[52:67]
    v_mfma_f32_32x32x16_bf16 v[68:83], v[104:107], v[84:87], v[68:83]
    buffer_load_dwordx4 v[84:87], v1, s[48:51], s60 offen sc1
    buffer_load_dwordx4 v[88:91], v1, s[48:51], s61 offen offset:0 sc1
    buffer_load_dwordx4 v[92:95], v1, s[48:51], s61 offen offset:1024 sc1
    buffer_load_dwordx4 v[96:99], v1, s[48:51], s61 offen offset:2048 sc1
    buffer_load_dwordx4 v[100:103], v1, s[48:51], s61 offen offset:3072 sc1
    buffer_load_dwordx4 v[104:107], v2, s[48:51], s61 offen sc1
    s_add_u32 s60, s60, 1024
    s_add_u32 s61, s61, 20480
    s_waitcnt vmcnt(12)
    v_mfma_f32_32x32x16_bf16 v[4:19], v[112:115], v[108:111], v[4:19]
    v_mfma_f32_32x32x16_bf16 v[20:35], v[116:119], v[108:111], v[20:35]
    v_mfma_f32_32x32x16_bf16 v[36:51], v[120:123], v[108:111], v[36:51]
    v_mfma_f32_32x32x16_bf16 v[52:67], v[124:127], v[108:111], v[52:67]
    v_mfma_f32_32x32x16_bf16 v[68:83], v[128:131], v[108:111], v[68:83]
    buffer_load_dwordx4 v[108:111], v1, s[48:51], s60 offen sc1
    buffer_load_dwordx4 v[112:115], v1, s[48:51], s61 offen offset:0 sc1
    buffer_load_dwordx4 v[116:119], v1, s[48:51], s61 offen offset:1024 sc1
    buffer_load_dwordx4 v[120:123], v1, s[48:51], s61 offen offset:2048 sc1
    buffer_load_dwordx4 v[124:127], v1, s[48:51], s61 offen offset:3072 sc1
    buffer_load_dwordx4 v[128:131], v2, s[48:51], s61 offen sc1
    s_add_u32 s60, s60, 1024
    s_add_u32 s61, s61, 20480
    s_waitcnt vmcnt(12)
    v_mfma_f32_32x32x16_bf16 v[4:19], v[136:139], v[132:135], v[4:19]
    v_mfma_f32_32x32x16_bf16 v[20:35], v[140:143], v[132:135], v[20:35]
    v_mfma_f32_32x32x16_bf16 v[36:51], v[144:147], v[132:135], v[36:51]
    v_mfma_f32_32x32x16_bf16 v[52:67], v[148:151], v[132:135], v[52:67]
    v_mfma_f32_32x32x16_bf16 v[68:83], v[152:155], v[132:135], v[68:83]
    buffer_load_dwordx4 v[132:135], v1, s[48:51], s60 offen sc1
    buffer_load_dwordx4 v[136:139], v1, s[48:51], s61 offen offset:0 sc1
    buffer_load_dwordx4 v[140:143], v1, s[48:51], s61 offen offset:1024 sc1
    buffer_load_dwordx4 v[144:147], v1, s[48:51], s61 offen offset:2048 sc1
    buffer_load_dwordx4 v[148:151], v1, s[48:51], s61 offen offset:3072 sc1
    buffer_load_dwordx4 v[152:155], v2, s[48:51], s61 offen sc1
    s_add_u32 s60, s60, 1024
    s_add_u32 s61, s61, 20480
    s_sub_u32 s73, s73, 1
    s_cmp_lg_u32 s73, 0
    s_cbranch_scc1 K2_GLOOP
    s_waitcnt vmcnt(12)
    v_mfma_f32_32x32x16_bf16 v[4:19], v[88:91], v[84:87], v[4:19]
    v_mfma_f32_32x32x16_bf16 v[20:35], v[92:95], v[84:87], v[20:35]
    v_mfma_f32_32x32x16_bf16 v[36:51], v[96:99], v[84:87], v[36:51]
    v_mfma_f32_32x32x16_bf16 v[52:67], v[100:103], v[84:87], v[52:67]
    v_mfma_f32_32x32x16_bf16 v[68:83], v[104:107], v[84:87], v[68:83]
    s_waitcnt vmcnt(6)
    v_mfma_f32_32x32x16_bf16 v[4:19], v[112:115], v[108:111], v[4:19]
    v_mfma_f32_32x32x16_bf16 v[20:35], v[116:119], v[108:111], v[20:35]
    v_mfma_f32_32x32x16_bf16 v[36:51], v[120:123], v[108:111], v[36:51]
    v_mfma_f32_32x32x16_bf16 v[52:67], v[124:127], v[108:111], v[52:67]
    v_mfma_f32_32x32x16_bf16 v[68:83], v[128:131], v[108:111], v[68:83]
    s_waitcnt vmcnt(0)
    v_mfma_f32_32x32x16_bf16 v[4:19], v[136:139], v[132:135], v[4:19]
    v_mfma_f32_32x32x16_bf16 v[20:35], v[140:143], v[132:135], v[20:35]
    v_mfma_f32_32x32x16_bf16 v[36:51], v[144:147], v[132:135], v[36:51]
    v_mfma_f32_32x32x16_bf16 v[52:67], v[148:151], v[132:135], v[52:67]
    v_mfma_f32_32x32x16_bf16 v[68:83], v[152:155], v[132:135], v[68:83]
    v_and_b32 v3, 31, v0
    s_lshl_b32 s63, s55, 5
    v_add_u32 v3, s63, v3
    v_mul_u32_u24 v3, 1280, v3
    v_lshrrev_b32 v162, 5, v0
    v_lshl_add_u32 v3, v162, 3, v3
    s_mul_i32 s62, s56, 320
    s_lshl_b32 s63, s53, 4
    s_add_u32 s62, s62, s63
    buffer_load_dwordx2 v[152:153], v3, s[36:39], s62 offen offset:0
    buffer_load_dwordx2 v[154:155], v3, s[36:39], s62 offen offset:64
    buffer_load_dwordx2 v[156:157], v3, s[36:39], s62 offen offset:128
    buffer_load_dwordx2 v[158:159], v3, s[36:39], s62 offen offset:192
    buffer_load_dwordx2 v[160:161], v3, s[36:39], s62 offen offset:256
    s_mov_b32 s64, s62
    s_mul_i32 s63, s53, 20480
    v_add_u32 v162, s63, v1
    s_lshl_b32 s63, s53, 10
    v_add_u32 v163, s63, v1
    v_add_u32 v164, 40960, v163
    s_mul_i32 s65, s56, 5120
    s_add_u32 s65, s65, 11047936
    s_barrier
    ds_write_b128 v162, v[4:7] offset:0
    ds_write_b128 v162, v[8:11] offset:1024
    ds_write_b128 v162, v[12:15] offset:2048
    ds_write_b128 v162, v[16:19] offset:3072
    ds_write_b128 v162, v[20:23] offset:4096
    ds_write_b128 v162, v[24:27] offset:5120
    ds_write_b128 v162, v[28:31] offset:6144
    ds_write_b128 v162, v[32:35] offset:7168
    ds_write_b128 v162, v[36:39] offset:8192
    ds_write_b128 v162, v[40:43] offset:9216
    ds_write_b128 v162, v[44:47] offset:10240
    ds_write_b128 v162, v[48:51] offset:11264
    ds_write_b128 v162, v[52:55] offset:12288
    ds_write_b128 v162, v[56:59] offset:13312
    ds_write_b128 v162, v[60:63] offset:14336
    ds_write_b128 v162, v[64:67] offset:15360
    ds_write_b128 v162, v[68:71] offset:16384
    ds_write_b128 v162, v[72:75] offset:17408
    ds_write_b128 v162, v[76:79] offset:18432
    ds_write_b128 v162, v[80:83] offset:19456
    s_add_u32 s62, s53, 0
    s_mul_i32 s63, s62, 52
    s_lshr_b32 s63, s63, 8
    s_mul_i32 s63, s63, 15360
    s_lshl_b32 s62, s62, 10
    s_add_u32 s63, s63, s62
    s_add_u32 s63, s63, s65
    s_add_u32 m0, s62, 81920
    s_nop 0
    buffer_load_dwordx4 v1, s[48:51], s63 offen sc1 lds
    s_add_u32 s62, s53, 4
    s_mul_i32 s63, s62, 52
    s_lshr_b32 s63, s63, 8
    s_mul_i32 s63, s63, 15360
    s_lshl_b32 s62, s62, 10
    s_add_u32 s63, s63, s62
    s_add_u32 s63, s63, s65
    s_add_u32 m0, s62, 81920
    s_nop 0
    buffer_load_dwordx4 v1, s[48:51], s63 offen sc1 lds
    s_add_u32 s62, s53, 8
    s_mul_i32 s63, s62, 52
    s_lshr_b32 s63, s63, 8
    s_mul_i32 s63, s63, 15360
    s_lshl_b32 s62, s62, 10
    s_add_u32 s63, s63, s62
    s_add_u32 s63, s63, s65
    s_add_u32 m0, s62, 81920
    s_nop 0
    buffer_load_dwordx4 v1, s[48:51], s63 offen sc1 lds
    s_add_u32 s62, s53, 12
    s_mul_i32 s63, s62, 52
    s_lshr_b32 s63, s63, 8
    s_mul_i32 s63, s63, 15360
    s_lshl_b32 s62, s62, 10
    s_add_u32 s63, s63, s62
    s_add_u32 s63, s63, s65
    s_add_u32 m0, s62, 81920
    s_nop 0
    buffer_load_dwordx4 v1, s[48:51], s63 offen sc1 lds
    s_add_u32 s62, s53, 16
    s_mul_i32 s63, s62, 52
    s_lshr_b32 s63, s63, 8
    s_mul_i32 s63, s63, 15360
    s_lshl_b32 s62, s62, 10
    s_add_u32 s63, s63, s62
    s_add_u32 s63, s63, s65
    s_add_u32 m0, s62, 81920
    s_nop 0
    buffer_load_dwordx4 v1, s[48:51], s63 offen sc1 lds
    s_add_u32 s62, s53, 20
    s_mul_i32 s63, s62, 52
    s_lshr_b32 s63, s63, 8
    s_mul_i32 s63, s63, 15360
    s_lshl_b32 s62, s62, 10
    s_add_u32 s63, s63, s62
    s_add_u32 s63, s63, s65
    s_add_u32 m0, s62, 81920
    s_nop 0
    buffer_load_dwordx4 v1, s[48:51], s63 offen sc1 lds
    s_add_u32 s62, s53, 24
    s_mul_i32 s63, s62, 52
    s_lshr_b32 s63, s63, 8
    s_mul_i32 s63, s63, 15360
    s_lshl_b32 s62, s62, 10
    s_add_u32 s63, s63, s62
    s_add_u32 s63, s63, s65
    s_add_u32 m0, s62, 81920
    s_nop 0
    buffer_load_dwordx4 v1, s[48:51], s63 offen sc1 lds
    s_add_u32 s62, s53, 28
    s_mul_i32 s63, s62, 52
    s_lshr_b32 s63, s63, 8
    s_mul_i32 s63, s63, 15360
    s_lshl_b32 s62, s62, 10
    s_add_u32 s63, s63, s62
    s_add_u32 s63, s63, s65
    s_add_u32 m0, s62, 81920
    s_nop 0
    buffer_load_dwordx4 v1, s[48:51], s63 offen sc1 lds
    s_add_u32 s62, s53, 32
    s_mul_i32 s63, s62, 52
    s_lshr_b32 s63, s63, 8
    s_mul_i32 s63, s63, 15360
    s_lshl_b32 s62, s62, 10
    s_add_u32 s63, s63, s62
    s_add_u32 s63, s63, s65
    s_add_u32 m0, s62, 81920
    s_nop 0
    buffer_load_dwordx4 v1, s[48:51], s63 offen sc1 lds
    s_waitcnt lgkmcnt(0)
    s_lshl_b32 s62, s53, 10
    s_add_u32 s62, s62, s65
    s_add_u32 s62, s62, 327680
    buffer_load_dwordx4 v[4:7], v1, s[48:51], s62 offen sc1
    s_add_u32 s62, s62, 20480
    buffer_load_dwordx4 v[8:11], v1, s[48:51], s62 offen sc1
    s_add_u32 s62, s62, 20480
    buffer_load_dwordx4 v[12:15], v1, s[48:51], s62 offen sc1
    s_add_u32 s62, s62, 20480
    buffer_load_dwordx4 v[16:19], v1, s[48:51], s62 offen sc1
    s_add_u32 s62, s62, 20480
    buffer_load_dwordx4 v[20:23], v1, s[48:51], s62 offen sc1
    s_add_u32 s62, s62, 20480
    buffer_load_dwordx4 v[24:27], v1, s[48:51], s62 offen sc1
    s_add_u32 s62, s62, 20480
    buffer_load_dwordx4 v[28:31], v1, s[48:51], s62 offen sc1
    s_add_u32 s62, s62, 20480
    buffer_load_dwordx4 v[32:35], v1, s[48:51], s62 offen sc1
    s_add_u32 s62, s62, 20480
    buffer_load_dwordx4 v[36:39], v1, s[48:51], s62 offen sc1
    s_add_u32 s62, s62, 20480
    buffer_load_dwordx4 v[40:43], v1, s[48:51], s62 offen sc1
    s_add_u32 s62, s62, 20480
    buffer_load_dwordx4 v[44:47], v1, s[48:51], s62 offen sc1
    s_add_u32 s62, s62, 20480
    buffer_load_dwordx4 v[48:51], v1, s[48:51], s62 offen sc1
    s_add_u32 s62, s62, 20480
    buffer_load_dwordx4 v[52:55], v1, s[48:51], s62 offen sc1
    s_add_u32 s62, s62, 20480
    buffer_load_dwordx4 v[56:59], v1, s[48:51], s62 offen sc1
    s_add_u32 s62, s62, 20480
    buffer_load_dwordx4 v[60:63], v1, s[48:51], s62 offen sc1
    s_add_u32 s62, s62, 20480
    buffer_load_dwordx4 v[64:67], v1, s[48:51], s62 offen sc1
    s_add_u32 s62, s62, 20480
    buffer_load_dwordx4 v[68:71], v1, s[48:51], s62 offen sc1
    s_add_u32 s62, s62, 20480
    buffer_load_dwordx4 v[72:75], v1, s[48:51], s62 offen sc1
    s_add_u32 s62, s62, 20480
    buffer_load_dwordx4 v[76:79], v1, s[48:51], s62 offen sc1
    s_add_u32 s62, s62, 20480
    buffer_load_dwordx4 v[80:83], v1, s[48:51], s62 offen sc1
    s_add_u32 s62, s62, 20480
    buffer_load_dwordx4 v[84:87], v1, s[48:51], s62 offen sc1
    s_add_u32 s62, s62, 20480
    buffer_load_dwordx4 v[88:91], v1, s[48:51], s62 offen sc1
    s_add_u32 s62, s62, 20480
    buffer_load_dwordx4 v[92:95], v1, s[48:51], s62 offen sc1
    s_add_u32 s62, s62, 20480
    buffer_load_dwordx4 v[96:99], v1, s[48:51], s62 offen sc1
    s_add_u32 s62, s62, 20480
    s_barrier
    s_add_u32 s62, s53, 36
    s_mul_i32 s63, s62, 52
    s_lshr_b32 s63, s63, 8
    s_mul_i32 s63, s63, 15360
    s_lshl_b32 s62, s62, 10
    s_add_u32 s63, s63, s62
    s_add_u32 s63, s63, s65
    s_add_u32 m0, s62, 81920
    s_nop 0
    buffer_load_dwordx4 v1, s[48:51], s63 offen sc1 lds
    s_waitcnt vmcnt(34)
    ds_read_b128 v[120:123], v163 offset:0
    ds_read_b128 v[124:127], v163 offset:20480
    ds_read_b128 v[128:131], v164 offset:0
    ds_read_b128 v[132:135], v164 offset:20480
    ds_read_b128 v[136:139], v163 offset:4096
    ds_read_b128 v[140:143], v163 offset:24576
    ds_read_b128 v[144:147], v164 offset:4096
    ds_read_b128 v[148:151], v164 offset:24576
    s_waitcnt lgkmcnt(4)
    v_lshlrev_b32 v100, 16, v152
    v_and_b32 v101, 0xffff0000, v152
    v_lshlrev_b32 v102, 16, v153
    v_and_b32 v103, 0xffff0000, v153
    v_add_f32 v120, v120, v124
    v_add_f32 v128, v128, v132
    v_add_f32 v121, v121, v125
    v_add_f32 v129, v129, v133
    v_add_f32 v122, v122, v126
    v_add_f32 v130, v130, v134
    v_add_f32 v123, v123, v127
    v_add_f32 v131, v131, v135
    v_add_f32 v120, v120, v128
    v_add_f32 v121, v121, v129
    v_add_f32 v122, v122, v130
    v_add_f32 v123, v123, v131
    v_add_f32 v100, v100, v120
    v_add_f32 v101, v101, v121
    v_add_f32 v102, v102, v122
    v_add_f32 v103, v103, v123
    ds_read_b128 v[120:123], v163 offset:8192
    ds_read_b128 v[124:127], v163 offset:28672
    ds_read_b128 v[128:131], v164 offset:8192
    ds_read_b128 v[132:135], v164 offset:28672
    s_waitcnt lgkmcnt(4)
    v_lshlrev_b32 v104, 16, v154
    v_and_b32 v105, 0xffff0000, v154
    v_lshlrev_b32 v106, 16, v155
    v_and_b32 v107, 0xffff0000, v155
    v_add_f32 v136, v136, v140
    v_add_f32 v144, v144, v148
    v_add_f32 v137, v137, v141
    v_add_f32 v145, v145, v149
    v_add_f32 v138, v138, v142
    v_add_f32 v146, v146, v150
    v_add_f32 v139, v139, v143
    v_add_f32 v147, v147, v151
    v_add_f32 v136, v136, v144
    v_add_f32 v137, v137, v145
    v_add_f32 v138, v138, v146
    v_add_f32 v139, v139, v147
    v_add_f32 v104, v104, v136
    v_add_f32 v105, v105, v137
    v_add_f32 v106, v106, v138
    v_add_f32 v107, v107, v139
    ds_read_b128 v[136:139], v163 offset:12288
    ds_read_b128 v[140:143], v163 offset:32768
    ds_read_b128 v[144:147], v164 offset:12288
    ds_read_b128 v[148:151], v164 offset:32768
    s_waitcnt lgkmcnt(4)
    v_lshlrev_b32 v108, 16, v156
    v_and_b32 v109, 0xffff0000, v156
    v_lshlrev_b32 v110, 16, v157
    v_and_b32 v111, 0xffff0000, v157
    v_add_f32 v120, v120, v124
    v_add_f32 v128, v128, v132
    v_add_f32 v121, v121, v125
    v_add_f32 v129, v129, v133
    v_add_f32 v122, v122, v126
    v_add_f32 v130, v130, v134
    v_add_f32 v123, v123, v127
    v_add_f32 v131, v131, v135
    v_add_f32 v120, v120, v128
    v_add_f32 v121, v121, v129
    v_add_f32 v122, v122, v130
    v_add_f32 v123, v123, v131
    v_add_f32 v108, v108, v120
    v_add_f32 v109, v109, v121
    v_add_f32 v110, v110, v122
    v_add_f32 v111, v111, v123
    ds_read_b128 v[120:123], v163 offset:16384
    ds_read_b128 v[124:127], v163 offset:36864
    ds_read_b128 v[128:131], v164 offset:16384
    ds_read_b128 v[132:135], v164 offset:36864
    s_waitcnt lgkmcnt(4)
    v_lshlrev_b32 v112, 16, v158
    v_and_b32 v113, 0xffff0000, v158
    v_lshlrev_b32 v114, 16, v159
    v_and_b32 v115, 0xffff0000, v159
    v_add_f32 v136, v136, v140
    v_add_f32 v144, v144, v148
    v_add_f32 v137, v137, v141
    v_add_f32 v145, v145, v149
    v_add_f32 v138, v138, v142
    v_add_f32 v146, v146, v150
    v_add_f32 v139, v139, v143
    v_add_f32 v147, v147, v151
    v_add_f32 v136, v136, v144
    v_add_f32 v137, v137, v145
    v_add_f32 v138, v138, v146
    v_add_f32 v139, v139, v147
    v_add_f32 v112, v112, v136
    v_add_f32 v113, v113, v137
    v_add_f32 v114, v114, v138
    v_add_f32 v115, v115, v139
    s_waitcnt lgkmcnt(0)
    v_lshlrev_b32 v116, 16, v160
    v_and_b32 v117, 0xffff0000, v160
    v_lshlrev_b32 v118, 16, v161
    v_and_b32 v119, 0xffff0000, v161
    v_add_f32 v120, v120, v124
    v_add_f32 v128, v128, v132
    v_add_f32 v121, v121, v125
    v_add_f32 v129, v129, v133
    v_add_f32 v122, v122, v126
    v_add_f32 v130, v130, v134
    v_add_f32 v123, v123, v127
    v_add_f32 v131, v131, v135
    v_add_f32 v120, v120, v128
    v_add_f32 v121, v121, v129
    v_add_f32 v122, v122, v130
    v_add_f32 v123, v123, v131
    v_add_f32 v116, v116, v120
    v_add_f32 v117, v117, v121
    v_add_f32 v118, v118, v122
    v_add_f32 v119, v119, v123
    s_mov_b32 s36, s18
    s_mov_b32 s37, s19
    s_mov_b32 s38, 2621440
    s_mov_b32 s39, 0x00020000
    v_add_u32 v2, 139264, v1
    s_waitcnt vmcnt(0)
    s_barrier
    s_barrier
    s_barrier
    ds_read_b128 v[136:139], v2 offset:0
    ds_read_b128 v[140:143], v2 offset:1024
    ds_read_b128 v[144:147], v2 offset:2048
    ds_read_b128 v[148:151], v2 offset:3072
    ds_read_b128 v[152:155], v2 offset:4096
    ds_read_b128 v[156:159], v2 offset:5120
    s_waitcnt lgkmcnt(5)
    v_mfma_f32_32x32x16_bf16 v[120:135], v[4:7], v[136:139], 0
    s_waitcnt lgkmcnt(4)
    v_mfma_f32_32x32x16_bf16 v[120:135], v[8:11], v[140:143], v[120:135]
    ds_read_b128 v[136:139], v2 offset:6144
    s_waitcnt lgkmcnt(4)
    v_mfma_f32_32x32x16_bf16 v[120:135], v[12:15], v[144:147], v[120:135]
    ds_read_b128 v[140:143], v2 offset:7168
    s_waitcnt lgkmcnt(4)
    v_mfma_f32_32x32x16_bf16 v[120:135], v[16:19], v[148:151], v[120:135]
    ds_read_b128 v[144:147], v2 offset:8192
    s_waitcnt lgkmcnt(4)
    v_mfma_f32_32x32x16_bf16 v[120:135], v[20:23], v[152:155], v[120:135]
    ds_read_b128 v[148:151], v2 offset:9216
    s_waitcnt lgkmcnt(4)
    v_mfma_f32_32x32x16_bf16 v[120:135], v[24:27], v[156:159], v[120:135]
    ds_read_b128 v[152:155], v2 offset:10240
    s_waitcnt lgkmcnt(4)
    v_mfma_f32_32x32x16_bf16 v[120:135], v[28:31], v[136:139], v[120:135]
    ds_read_b128 v[156:159], v2 offset:11264
    s_waitcnt lgkmcnt(4)
    v_mfma_f32_32x32x16_bf16 v[120:135], v[32:35], v[140:143], v[120:135]
    ds_read_b128 v[136:139], v2 offset:12288
    s_waitcnt lgkmcnt(4)
    v_mfma_f32_32x32x16_bf16 v[120:135], v[36:39], v[144:147], v[120:135]
    ds_read_b128 v[140:143], v2 offset:13312
    s_waitcnt lgkmcnt(4)
    v_mfma_f32_32x32x16_bf16 v[120:135], v[40:43], v[148:151], v[120:135]
    ds_read_b128 v[144:147], v2 offset:14336
    s_waitcnt lgkmcnt(4)
    v_mfma_f32_32x32x16_bf16 v[120:135], v[44:47], v[152:155], v[120:135]
    ds_read_b128 v[148:151], v2 offset:15360
    s_waitcnt lgkmcnt(4)
    v_mfma_f32_32x32x16_bf16 v[120:135], v[48:51], v[156:159], v[120:135]
    ds_read_b128 v[152:155], v2 offset:16384
    s_waitcnt lgkmcnt(4)
    v_mfma_f32_32x32x16_bf16 v[120:135], v[52:55], v[136:139], v[120:135]
    ds_read_b128 v[156:159], v2 offset:17408
    s_waitcnt lgkmcnt(4)
    v_mfma_f32_32x32x16_bf16 v[120:135], v[56:59], v[140:143], v[120:135]
    ds_read_b128 v[136:139], v2 offset:18432
    s_waitcnt lgkmcnt(4)
    v_mfma_f32_32x32x16_bf16 v[120:135], v[60:63], v[144:147], v[120:135]
    ds_read_b128 v[140:143], v2 offset:19456
    s_waitcnt lgkmcnt(4)
    v_mfma_f32_32x32x16_bf16 v[120:135], v[64:67], v[148:151], v[120:135]
    ds_read_b128 v[144:147], v2 offset:20480
    s_waitcnt lgkmcnt(4)
    v_mfma_f32_32x32x16_bf16 v[120:135], v[68:71], v[152:155], v[120:135]
    ds_read_b128 v[148:151], v2 offset:21504
    s_waitcnt lgkmcnt(4)
    v_mfma_f32_32x32x16_bf16 v[120:135], v[72:75], v[156:159], v[120:135]
    ds_read_b128 v[152:155], v2 offset:22528
    s_waitcnt lgkmcnt(4)
    v_mfma_f32_32x32x16_bf16 v[120:135], v[76:79], v[136:139], v[120:135]
    ds_read_b128 v[156:159], v2 offset:23552
    s_waitcnt lgkmcnt(4)
    v_mfma_f32_32x32x16_bf16 v[120:135], v[80:83], v[140:143], v[120:135]
    s_waitcnt lgkmcnt(3)
    v_mfma_f32_32x32x16_bf16 v[120:135], v[84:87], v[144:147], v[120:135]
    s_waitcnt lgkmcnt(2)
    v_mfma_f32_32x32x16_bf16 v[120:135], v[88:91], v[148:151], v[120:135]
    s_waitcnt lgkmcnt(1)
    v_mfma_f32_32x32x16_bf16 v[120:135], v[92:95], v[152:155], v[120:135]
    s_waitcnt lgkmcnt(0)
    v_mfma_f32_32x32x16_bf16 v[120:135], v[96:99], v[156:159], v[120:135]
    s_lshl_b32 s63, s53, 13
    s_add_u32 s63, s63, 4096
    v_add_u32 v2, s63, v1
    s_nop 8
    ds_write_b128 v2, v[120:123] offset:0
    ds_write_b128 v2, v[124:127] offset:1024
    ds_write_b128 v2, v[128:131] offset:2048
    ds_write_b128 v2, v[132:135] offset:3072
    s_waitcnt lgkmcnt(0)
    s_barrier
    ds_read_b128 v[4:7], v163 offset:0
    ds_read_b128 v[8:11], v163 offset:4096
    ds_read_b128 v[12:15], v163 offset:8192
    ds_read_b128 v[16:19], v163 offset:12288
    ds_read_b128 v[20:23], v163 offset:16384
    ds_read_b128 v[24:27], v163 offset:20480
    ds_read_b128 v[28:31], v163 offset:24576
    ds_read_b128 v[32:35], v163 offset:28672
    ds_read_b128 v[36:39], v163 offset:32768
    ds_read_b128 v[40:43], v163 offset:36864
    ds_read_b128 v[44:47], v163 offset:40960
    ds_read_b128 v[48:51], v163 offset:45056
    s_waitcnt lgkmcnt(10)
    v_add_f32 v100, v100, v4
    v_add_f32 v101, v101, v5
    v_add_f32 v102, v102, v6
    v_add_f32 v103, v103, v7
    v_add_f32 v100, v100, v8
    v_add_f32 v101, v101, v9
    v_add_f32 v102, v102, v10
    v_add_f32 v103, v103, v11
    v_cvt_pk_bf16_f32 v100, v100, v101
    v_cvt_pk_bf16_f32 v101, v102, v103
    buffer_store_dwordx2 v[100:101], v3, s[36:39], s64 offen offset:0
    s_waitcnt lgkmcnt(8)
    v_add_f32 v104, v104, v12
    v_add_f32 v105, v105, v13
    v_add_f32 v106, v106, v14
    v_add_f32 v107, v107, v15
    v_add_f32 v104, v104, v16
    v_add_f32 v105, v105, v17
    v_add_f32 v106, v106, v18
    v_add_f32 v107, v107, v19
    v_cvt_pk_bf16_f32 v104, v104, v105
    v_cvt_pk_bf16_f32 v105, v106, v107
    buffer_store_dwordx2 v[104:105], v3, s[36:39], s64 offen offset:64
    s_waitcnt lgkmcnt(6)
    v_add_f32 v108, v108, v20
    v_add_f32 v109, v109, v21
    v_add_f32 v110, v110, v22
    v_add_f32 v111, v111, v23
    v_add_f32 v108, v108, v24
    v_add_f32 v109, v109, v25
    v_add_f32 v110, v110, v26
    v_add_f32 v111, v111, v27
    v_cvt_pk_bf16_f32 v108, v108, v109
    v_cvt_pk_bf16_f32 v109, v110, v111
    buffer_store_dwordx2 v[108:109], v3, s[36:39], s64 offen offset:128
    s_waitcnt lgkmcnt(4)
    v_add_f32 v112, v112, v28
    v_add_f32 v113, v113, v29
    v_add_f32 v114, v114, v30
    v_add_f32 v115, v115, v31
    v_add_f32 v112, v112, v32
    v_add_f32 v113, v113, v33
    v_add_f32 v114, v114, v34
    v_add_f32 v115, v115, v35
    v_cvt_pk_bf16_f32 v112, v112, v113
    v_cvt_pk_bf16_f32 v113, v114, v115
    buffer_store_dwordx2 v[112:113], v3, s[36:39], s64 offen offset:192
    s_waitcnt lgkmcnt(0)
    v_add_f32 v116, v116, v36
    v_add_f32 v117, v117, v37
    v_add_f32 v118, v118, v38
    v_add_f32 v119, v119, v39
    v_add_f32 v116, v116, v40
    v_add_f32 v117, v117, v41
    v_add_f32 v118, v118, v42
    v_add_f32 v119, v119, v43
    v_add_f32 v116, v116, v44
    v_add_f32 v117, v117, v45
    v_add_f32 v118, v118, v46
    v_add_f32 v119, v119, v47
    v_add_f32 v116, v116, v48
    v_add_f32 v117, v117, v49
    v_add_f32 v118, v118, v50
    v_add_f32 v119, v119, v51
    v_cvt_pk_bf16_f32 v116, v116, v117
    v_cvt_pk_bf16_f32 v117, v118, v119
    buffer_store_dwordx2 v[116:117], v3, s[36:39], s64 offen offset:256
K2_END:
    s_endpgm
.section .rodata,"a"
.p2align 6
.amdhsa_kernel parallel_sum__grouped_kv_mqa__glu_gated_swiglu__prompt_kernel
  .amdhsa_next_free_vgpr 168
  .amdhsa_next_free_sgpr 102
  .amdhsa_accum_offset 168
  .amdhsa_group_segment_fixed_size 0
  .amdhsa_kernarg_size 96
  .amdhsa_user_sgpr_count 2
  .amdhsa_user_sgpr_kernarg_segment_ptr 1
  .amdhsa_system_sgpr_workgroup_id_x 1
.end_amdhsa_kernel
```
